```python
import torch

def _softmax(x, axis=-1):
    return torch.softmax(x, dim=axis)
def _gelu(x):
    return torch.nn.functional.gelu(x, approximate="tanh")
def _silu(x):
    return torch.nn.functional.silu(x)
def _sigmoid(x):
    return torch.sigmoid(x)
def _layernorm(x, axis=-1, eps=1e-5):
    m = x.mean(dim=axis, keepdim=True)
    v = x.var(dim=axis, keepdim=True, unbiased=False)
    return (x - m) / torch.sqrt(v + eps)
def _scatter_add(tgt, idx, src, axis=0):
    return tgt.clone().index_add_(axis, idx, src)
def _segment_sum(src, seg, n):
    out = torch.zeros((n,) + src.shape[1:], dtype=src.dtype)
    return out.index_add_(0, seg, src)
def _pad(x, pw):
    flat = tuple(v for pair in reversed(pw) for v in pair)
    return torch.nn.functional.pad(x, flat)

kernel_name = 'interleave_layers__sliding_block__ssm_conv_h3__prompt'

def setup_inputs():

    _w = (lambda a: (lambda t: t.to(torch.bfloat16) if t.is_floating_point() else t)(torch.as_tensor(a)))
    def _A_setup():
        B, S, D = 1, 2048, 640
        return {
            "x": _w((lambda *s: torch.randn(*s, dtype=torch.bfloat16) * 0.05)(B, S, D)),
            "wqkv": _w((lambda *s: torch.randn(*s, dtype=torch.bfloat16) * 0.05)(D, 3 * D)),
            "wo": _w((lambda *s: torch.randn(*s, dtype=torch.bfloat16) * 0.05)(D, D)),
        }
    _A_in = _A_setup()

    def _B_setup():
        B, S, D = 1, 2048, 640
        ks = 4
        return {
            "q": _w((lambda *s: torch.randn(*s, dtype=torch.bfloat16) * 0.05)(B, S, D)),
            "k": _w((lambda *s: torch.randn(*s, dtype=torch.bfloat16) * 0.4)(B, S, D)),
            "v": _w((lambda *s: torch.randn(*s, dtype=torch.bfloat16) * 0.4)(B, S, D)),
            "shift_k": _w((lambda *s: torch.randn(*s, dtype=torch.bfloat16) * 0.4)(D, ks) * 0.5),
            "ssm_k": _w((lambda *s: torch.randn(*s, dtype=torch.bfloat16) * 0.8)(D, S) * (1.0 / S ** 0.5)),
            "ssm_D": _w((lambda *s: torch.randn(*s, dtype=torch.bfloat16) * 0.4)(D)),
        }
    _B_in = _B_setup()

    return {
        "A_x": _A_in["x"],
        "A_wqkv": _A_in["wqkv"],
        "A_wo": _A_in["wo"],
        "B_q": _B_in["q"],
        "B_k": _B_in["k"],
        "B_v": _B_in["v"],
        "B_shift_k": _B_in["shift_k"],
        "B_ssm_k": _B_in["ssm_k"],
        "B_ssm_D": _B_in["ssm_D"],
    }

def reference(A_x, A_wqkv, A_wo, B_q, B_k, B_v, B_shift_k, B_ssm_k, B_ssm_D):
    def _A_ref(x, wqkv, wo):
        B, S, D = x.shape
        H = 32; Dh = D // H; W = 256
        qkv = (lambda x, *d: x.permute(*d))((x @ wqkv).reshape(B, S, 3, H, Dh), 2, 0, 3, 1, 4)
        q, k, v = qkv[0], qkv[1], qkv[2]
        scores = torch.einsum("bhqd,bhkd->bhqk", q, k) * (Dh ** -0.5)
        idx = torch.arange(S)
        mask = (idx[:, None] - idx[None, :] >= 0) & (idx[:, None] - idx[None, :] < W)
        scores = torch.where(mask[None, None], scores, -1e9)
        p = _softmax(scores, axis=-1)
        o = torch.einsum("bhqk,bhkd->bhqd", p, v)
        return (lambda x, *d: x.permute(*d))(o, 0, 2, 1, 3).reshape(B, S, D) @ wo

    def _B_ref(q, k, v, shift_k, ssm_k, ssm_D):
        B, S, D = q.shape
        ks = shift_k.shape[-1]
        k_pad = _pad(k, ((0, 0), (ks - 1, 0), (0, 0)))
        k_shift = torch.zeros_like(k)
        for t in range(ks):
            k_shift = k_shift + k_pad[:, t:t + S, :] * shift_k[:, ks - 1 - t][None, None, :]
        kv = k_shift * v
        L = 2 * S
        kv_pad = _pad(kv, ((0, 0), (0, S), (0, 0)))
        kf_pad = _pad(ssm_k, ((0, 0), (0, S)))
        kv_f = (lambda x, axes=(-2,-1): torch.fft.rfft2(x.float(), dim=axes))(kv_pad[:, None, :, :], axes=(1, 2))
        kf_f = (lambda x, axes=(-2,-1): torch.fft.rfft2(x.float(), dim=axes))(kf_pad[:, None, :], axes=(1, 2))
        kf_f = (lambda x, *d: x.permute(*d))(kf_f, 1, 2, 0)
        y_f = kv_f * kf_f[None, :, :, :]
        y = (lambda x, s, axes=(-2,-1): torch.fft.irfft2(x, s=s, dim=axes).to(torch.bfloat16))(y_f, (1, L), axes=(1, 2))[:, 0, :S, :]
        y = y + kv * ssm_D[None, None, :]
        return q * y

    x = A_x
    x = x + _A_ref(_layernorm(x, axis=-1), A_wqkv, A_wo)
    x = x + _B_ref(_layernorm(x, axis=-1), B_k, B_v, B_shift_k, B_ssm_k, B_ssm_D)
    x = x + _A_ref(_layernorm(x, axis=-1), A_wqkv, A_wo)
    x = x + _B_ref(_layernorm(x, axis=-1), B_k, B_v, B_shift_k, B_ssm_k, B_ssm_D)
    return x
```

```asm
; @launch grid=(256,1,1) block=(256,1,1) lds=163840
.amdgcn_target "amdgcn-amd-amdhsa--gfx950"
.text
.globl interleave_layers__sliding_block__ssm_conv_h3__prompt_kernel
.p2align 8
.type interleave_layers__sliding_block__ssm_conv_h3__prompt_kernel,@function
interleave_layers__sliding_block__ssm_conv_h3__prompt_kernel:
  s_cmp_ge_u32 s2, 256
  s_cbranch_scc1 L_END
  s_load_dwordx4 s[4:7], s[0:1], 0
  s_load_dwordx2 s[8:9], s[0:1], 16
  s_load_dwordx8 s[12:19], s[0:1], 32
  s_load_dwordx8 s[20:27], s[0:1], 64
  s_getpc_b64 s[100:101]
L_PC:
  v_and_b32 v1, 63, v0
  v_lshlrev_b32 v2, 4, v1
  v_lshlrev_b32 v3, 3, v1
  v_lshrrev_b32 v4, 6, v0
  s_and_b32 s28, s2, 7
  s_lshr_b32 s29, s2, 3
  v_readfirstlane_b32 s30, v4
  s_mov_b32 s64, 400000
  s_mov_b32 s32, 0
  s_mov_b32 s33, 0
  s_getreg_b32 s65, hwreg(HW_REG_XCC_ID, 0, 4)
  s_lshl_b32 s44, s28, 8
  s_lshl_b32 s45, s29, 3
  s_add_u32 s44, s44, s45
  s_lshl_b32 s45, s30, 1
  s_add_u32 s44, s44, s45
  s_mul_i32 s44, s44, 1280
  v_and_b32 v8, 1, v1
  v_mul_u32_u24 v8, 1280, v8
  v_lshrrev_b32 v9, 1, v1
  v_lshlrev_b32 v9, 4, v9
  v_add3_u32 v8, v8, v9, s44
  s_waitcnt lgkmcnt(0)
  v_mov_b32 v240, 0
  v_mov_b32 v241, 0
  v_mov_b32 v242, 0
  v_mov_b32 v243, 0
  global_load_dwordx4 v[232:235], v8, s[4:5] nt
  global_load_dwordx4 v[236:239], v8, s[4:5] offset:512 nt
  s_mov_b32 exec_lo, 0xffffffff
  s_mov_b32 exec_hi, 0x0
  global_load_dwordx4 v[240:243], v8, s[4:5] offset:1024 nt
  s_mov_b64 exec, -1
  v_mov_b32 v87, 0
  global_load_dword v87, v87, s[26:27] sc1
  s_lshr_b32 s44, s30, 1
  s_mul_i32 s88, s44, 24832
  s_add_u32 s88, s88, 81920
  s_mul_i32 s45, s28, 80
  s_lshl_b32 s89, s29, 1
  s_add_u32 s89, s89, s45
  s_add_u32 s89, s89, s44
  s_and_b32 s90, s30, 1
  s_lshr_b32 s91, s29, 1
  s_add_u32 s91, s91, s45
  s_add_u32 s91, s91, 64
  s_mov_b32 s36, s12
  s_mov_b32 s37, s13
  s_mov_b32 s38, 2621440
  s_mov_b32 s39, 0x00020000
  v_min_u32 v4, 159, v0
  v_mul_u32_u24 v140, 6554, v4
  v_lshrrev_b32 v140, 16, v140
  v_mul_u32_u24 v141, 10, v140
  v_sub_u32 v141, v4, v141
  s_lshl_b32 s44, s29, 6
  s_sub_u32 s44, s44, 3
  v_lshl_add_u32 v4, v140, 2, s44
  s_mov_b32 s45, 1280
  v_mul_lo_u32 v4, s45, v4
  s_mul_i32 s46, s28, 160
  v_lshl_add_u32 v5, v141, 4, s46
  v_add_u32 v4, v4, v5
  buffer_load_dwordx4 v[96:99], v4, s[36:39], 0 offen nt
  v_add_u32 v4, 1280, v4
  buffer_load_dwordx4 v[100:103], v4, s[36:39], 0 offen nt
  v_add_u32 v4, 1280, v4
  buffer_load_dwordx4 v[104:107], v4, s[36:39], 0 offen nt
  v_add_u32 v5, 1280, v4
  v_add_u32 v4, 1280, v4
  buffer_load_dwordx4 v[108:111], v4, s[36:39], 0 offen nt
  v_add_u32 v4, 1280, v4
  buffer_load_dwordx4 v[112:115], v4, s[36:39], 0 offen nt
  v_add_u32 v4, 1280, v4
  buffer_load_dwordx4 v[116:119], v4, s[36:39], 0 offen nt
  v_add_u32 v4, 1280, v4
  buffer_load_dwordx4 v[120:123], v4, s[36:39], 0 offen nt
  s_mov_b32 s36, s14
  s_mov_b32 s37, s15
  buffer_load_dwordx4 v[124:127], v5, s[36:39], 0 offen nt
  v_add_u32 v5, 1280, v5
  buffer_load_dwordx4 v[128:131], v5, s[36:39], 0 offen nt
  v_add_u32 v5, 1280, v5
  buffer_load_dwordx4 v[132:135], v5, s[36:39], 0 offen nt
  v_add_u32 v5, 1280, v5
  buffer_load_dwordx4 v[136:139], v5, s[36:39], 0 offen nt
  s_mul_i32 s46, s28, 640
  v_min_u32 v4, 39, v1
  v_lshl_add_u32 v4, v4, 4, s46
  global_load_dwordx4 v[164:167], v4, s[16:17] nt
  s_mov_b32 s36, s18
  s_mov_b32 s37, s19
  s_mov_b32 s38, 2621440
  s_mov_b32 s39, 0x00020000
  s_lshl_b32 s47, s89, 12
  v_and_b32 v4, 127, v0
  v_lshlrev_b32 v4, 4, v4
  buffer_load_dwordx4 v[168:171], v4, s[36:39], s47 offen offset:0 nt
  buffer_load_dwordx2 v[172:173], v4, s[36:39], s47 offen offset:16 nt
  buffer_load_dwordx4 v[176:179], v4, s[36:39], s47 offen offset:2048 nt
  buffer_load_dwordx2 v[180:181], v4, s[36:39], s47 offen offset:2064 nt
  s_lshr_b32 s48, s89, 1
  s_lshl_b32 s48, s48, 2
  v_mov_b32 v5, s48
  global_load_dword v186, v5, s[20:21] nt
  s_lshl_b32 s47, s91, 12
  v_lshlrev_b32 v4, 4, v0
  buffer_load_dwordx4 v[188:191], v4, s[36:39], s47 offen nt
  buffer_load_dwordx2 v[192:193], v4, s[36:39], s47 offen offset:16 nt
  s_lshr_b32 s48, s91, 1
  s_lshl_b32 s48, s48, 2
  v_mov_b32 v5, s48
  global_load_dword v194, v5, s[20:21] nt
  s_mul_i32 s44, s2, 9600
  v_lshlrev_b32 v4, 4, v0
  v_add_u32 v4, s44, v4
  global_load_dwordx4 v[208:211], v4, s[6:7]
  global_load_dwordx4 v[212:215], v4, s[6:7] offset:4080
  v_min_u32 v5, 89, v0
  v_lshlrev_b32 v5, 4, v5
  s_add_u32 s44, s44, 8160
  v_add_u32 v5, s44, v5
  global_load_dwordx4 v[216:219], v5, s[6:7]
  s_mul_i32 s44, s2, 3200
  v_min_u32 v5, 199, v0
  v_lshlrev_b32 v5, 4, v5
  v_add_u32 v5, s44, v5
  global_load_dwordx4 v[220:223], v5, s[8:9]
  v_min_u32 v5, 79, v0
  v_lshlrev_b32 v5, 9, v5
  s_lshr_b32 s44, s29, 2
  s_mul_i32 s44, s44, 40960
  s_and_b32 s45, s29, 3
  s_lshl_b32 s45, s45, 7
  s_add_u32 s44, s44, s45
  s_mul_i32 s45, s28, 327680
  s_add_u32 s44, s44, s45
  s_add_u32 s44, s44, 0x100000
  v_add_u32 v5, s44, v5
  global_load_dword v85, v5, s[26:27]
  v_min_u32 v5, 79, v0
  v_lshlrev_b32 v5, 12, v5
  s_mul_i32 s44, s28, 327680
  s_lshl_b32 s45, s29, 7
  s_sub_u32 s44, s44, s45
  s_add_u32 s44, s44, 0x1e00f80
  v_add_u32 v5, s44, v5
  s_lshl_b32 s44, s28, 12
  s_lshl_b32 s45, s29, 7
  s_add_u32 s44, s44, s45
  s_add_u32 s44, s44, 0x70000
  v_mov_b32 v4, s44
  v_cmp_gt_u32 vcc, 80, v0
  s_nop 1
  v_cndmask_b32 v5, v4, v5, vcc
  global_load_dword v84, v5, s[26:27]
  v_mov_b32 v92, 0
  v_mov_b32 v93, 0
  v_mov_b32 v94, 0
  v_mov_b32 v95, 0
  v_and_b32 v15, 31, v1
  v_lshlrev_b32 v15, 7, v15
  s_lshl_b32 s44, s29, 7
  v_mov_b32 v6, s44
  v_mov_b32 v4, 135104
  ds_write_b32 v4, v92
  v_mul_u32_u24 v8, 5462, v1
  v_lshrrev_b32 v8, 16, v8
  v_mul_u32_u24 v9, 12, v8
  v_sub_u32 v9, v1, v9
  v_lshrrev_b32 v10, 2, v9
  v_and_b32 v11, 3, v1
  s_mul_i32 s44, s30, 160
  v_add_u32 v8, s44, v8
  s_mov_b32 s45, 3840
  v_mul_lo_u32 v90, s45, v8
  v_mul_u32_u24 v91, 1280, v10
  v_lshlrev_b32 v14, 4, v11
  v_add3_u32 v90, v90, v91, v14
  s_mul_i32 s46, s29, 40
  v_add_u32 v90, s46, v90
  v_lshlrev_b32 v91, 5, v10
  v_add_u32 v91, v91, v14
  v_cmp_eq_u32 vcc, 2, v10
  v_add_u32 v5, 40992, v14
  s_nop 0
  v_cndmask_b32 v91, v91, v5, vcc
  v_lshlrev_b32 v5, 4, v10
  v_min_u32 v5, 24, v5
  v_add_u32 v5, 40960, v5
  v_cmp_eq_u32 vcc, 2, v11
  s_nop 1
  v_cndmask_b32 v91, v91, v5, vcc
  v_lshlrev_b32 v8, 6, v8
  v_add_u32 v91, v91, v8
  s_waitcnt vmcnt(14)
  v_readfirstlane_b32 s31, v87
  s_nop 0
  s_add_u32 s31, s31, 0x9e3779b9
  s_cmp_lg_u32 s30, 0
  s_cbranch_scc1 L_xp_1
  s_lshl_b32 s44, s28, 5
  s_add_u32 s44, s44, s29
  s_lshl_b32 s44, s44, 7
  s_add_u32 s44, s44, 0x1000
  s_add_u32 s45, s31, s65
  s_add_u32 s45, s45, 64
  v_mov_b32 v4, s44
  v_mov_b32 v5, s45
  s_mov_b32 exec_lo, 0x1
  s_mov_b32 exec_hi, 0x0
  global_store_dword v4, v5, s[26:27] sc1
  s_mov_b64 exec, -1
L_xp_1:
  v_min_u32 v4, 39, v1
  v_lshlrev_b32 v4, 4, v4
  v_add_u32 v4, 12288, v4
  ds_write_b128 v4, v[164:167]
  v_lshlrev_b32 v5, 6, v141
  v_add_u32 v5, 12288, v5
  s_waitcnt lgkmcnt(0)
  s_barrier
  ds_read_b128 v[144:147], v5 offset:0
  ds_read_b128 v[148:151], v5 offset:16
  ds_read_b128 v[152:155], v5 offset:32
  ds_read_b128 v[156:159], v5 offset:48
  v_cmp_gt_u32 vcc, 160, v0
  s_nop 0
  s_mov_b64 s[92:93], vcc
  v_mul_u32_u24 v10, 1168, v141
  v_lshlrev_b32 v11, 3, v140
  v_sub_u32 v10, v10, v11
  v_add_u32 v10, 120, v10
  s_waitcnt lgkmcnt(0)
  v_lshlrev_b32 v16, 16, v96
  v_and_b32 v17, 0xffff0000, v96
  v_lshlrev_b32 v18, 16, v100
  v_and_b32 v19, 0xffff0000, v100
  v_lshlrev_b32 v20, 16, v104
  v_and_b32 v21, 0xffff0000, v104
  v_lshlrev_b32 v22, 16, v108
  v_and_b32 v23, 0xffff0000, v108
  v_lshlrev_b32 v24, 16, v112
  v_and_b32 v25, 0xffff0000, v112
  v_lshlrev_b32 v26, 16, v116
  v_and_b32 v27, 0xffff0000, v116
  v_lshlrev_b32 v28, 16, v120
  v_and_b32 v29, 0xffff0000, v120
  v_lshlrev_b32 v30, 16, v144
  v_and_b32 v32, 0xffff0000, v144
  v_lshlrev_b32 v34, 16, v145
  v_and_b32 v36, 0xffff0000, v145
  v_lshlrev_b32 v31, 16, v146
  v_and_b32 v33, 0xffff0000, v146
  v_lshlrev_b32 v35, 16, v147
  v_and_b32 v37, 0xffff0000, v147
  v_lshlrev_b32 v38, 16, v124
  v_and_b32 v39, 0xffff0000, v124
  v_lshlrev_b32 v40, 16, v128
  v_and_b32 v41, 0xffff0000, v128
  v_lshlrev_b32 v42, 16, v132
  v_and_b32 v43, 0xffff0000, v132
  v_lshlrev_b32 v44, 16, v136
  v_and_b32 v45, 0xffff0000, v136
  v_pk_mul_f32 v[46:47], v[16:17], v[36:37]
  v_pk_mul_f32 v[48:49], v[18:19], v[36:37]
  v_pk_mul_f32 v[50:51], v[20:21], v[36:37]
  v_pk_mul_f32 v[52:53], v[22:23], v[36:37]
  v_pk_fma_f32 v[46:47], v[18:19], v[34:35], v[46:47]
  v_pk_fma_f32 v[48:49], v[20:21], v[34:35], v[48:49]
  v_pk_fma_f32 v[50:51], v[22:23], v[34:35], v[50:51]
  v_pk_fma_f32 v[52:53], v[24:25], v[34:35], v[52:53]
  v_pk_fma_f32 v[46:47], v[20:21], v[32:33], v[46:47]
  v_pk_fma_f32 v[48:49], v[22:23], v[32:33], v[48:49]
  v_pk_fma_f32 v[50:51], v[24:25], v[32:33], v[50:51]
  v_pk_fma_f32 v[52:53], v[26:27], v[32:33], v[52:53]
  v_pk_fma_f32 v[46:47], v[22:23], v[30:31], v[46:47]
  v_pk_fma_f32 v[48:49], v[24:25], v[30:31], v[48:49]
  v_pk_fma_f32 v[50:51], v[26:27], v[30:31], v[50:51]
  v_pk_fma_f32 v[52:53], v[28:29], v[30:31], v[52:53]
  v_pk_mul_f32 v[46:47], v[46:47], v[38:39]
  v_pk_mul_f32 v[48:49], v[48:49], v[40:41]
  v_pk_mul_f32 v[50:51], v[50:51], v[42:43]
  v_pk_mul_f32 v[52:53], v[52:53], v[44:45]
  v_cvt_pk_bf16_f32 v54, v52, v50
  v_cvt_pk_bf16_f32 v55, v48, v46
  v_cvt_pk_bf16_f32 v56, v53, v51
  v_cvt_pk_bf16_f32 v57, v49, v47
  s_mov_b64 exec, s[92:93]
  ds_write_b64 v10, v[54:55] offset:0
  ds_write_b64 v10, v[56:57] offset:144
  s_mov_b64 exec, -1
  v_lshlrev_b32 v16, 16, v97
  v_and_b32 v17, 0xffff0000, v97
  v_lshlrev_b32 v18, 16, v101
  v_and_b32 v19, 0xffff0000, v101
  v_lshlrev_b32 v20, 16, v105
  v_and_b32 v21, 0xffff0000, v105
  v_lshlrev_b32 v22, 16, v109
  v_and_b32 v23, 0xffff0000, v109
  v_lshlrev_b32 v24, 16, v113
  v_and_b32 v25, 0xffff0000, v113
  v_lshlrev_b32 v26, 16, v117
  v_and_b32 v27, 0xffff0000, v117
  v_lshlrev_b32 v28, 16, v121
  v_and_b32 v29, 0xffff0000, v121
  v_lshlrev_b32 v30, 16, v148
  v_and_b32 v32, 0xffff0000, v148
  v_lshlrev_b32 v34, 16, v149
  v_and_b32 v36, 0xffff0000, v149
  v_lshlrev_b32 v31, 16, v150
  v_and_b32 v33, 0xffff0000, v150
  v_lshlrev_b32 v35, 16, v151
  v_and_b32 v37, 0xffff0000, v151
  v_lshlrev_b32 v38, 16, v125
  v_and_b32 v39, 0xffff0000, v125
  v_lshlrev_b32 v40, 16, v129
  v_and_b32 v41, 0xffff0000, v129
  v_lshlrev_b32 v42, 16, v133
  v_and_b32 v43, 0xffff0000, v133
  v_lshlrev_b32 v44, 16, v137
  v_and_b32 v45, 0xffff0000, v137
  v_pk_mul_f32 v[46:47], v[16:17], v[36:37]
  v_pk_mul_f32 v[48:49], v[18:19], v[36:37]
  v_pk_mul_f32 v[50:51], v[20:21], v[36:37]
  v_pk_mul_f32 v[52:53], v[22:23], v[36:37]
  v_pk_fma_f32 v[46:47], v[18:19], v[34:35], v[46:47]
  v_pk_fma_f32 v[48:49], v[20:21], v[34:35], v[48:49]
  v_pk_fma_f32 v[50:51], v[22:23], v[34:35], v[50:51]
  v_pk_fma_f32 v[52:53], v[24:25], v[34:35], v[52:53]
  v_pk_fma_f32 v[46:47], v[20:21], v[32:33], v[46:47]
  v_pk_fma_f32 v[48:49], v[22:23], v[32:33], v[48:49]
  v_pk_fma_f32 v[50:51], v[24:25], v[32:33], v[50:51]
  v_pk_fma_f32 v[52:53], v[26:27], v[32:33], v[52:53]
  v_pk_fma_f32 v[46:47], v[22:23], v[30:31], v[46:47]
  v_pk_fma_f32 v[48:49], v[24:25], v[30:31], v[48:49]
  v_pk_fma_f32 v[50:51], v[26:27], v[30:31], v[50:51]
  v_pk_fma_f32 v[52:53], v[28:29], v[30:31], v[52:53]
  v_pk_mul_f32 v[46:47], v[46:47], v[38:39]
  v_pk_mul_f32 v[48:49], v[48:49], v[40:41]
  v_pk_mul_f32 v[50:51], v[50:51], v[42:43]
  v_pk_mul_f32 v[52:53], v[52:53], v[44:45]
  v_cvt_pk_bf16_f32 v58, v52, v50
  v_cvt_pk_bf16_f32 v59, v48, v46
  v_cvt_pk_bf16_f32 v60, v53, v51
  v_cvt_pk_bf16_f32 v61, v49, v47
  s_mov_b64 exec, s[92:93]
  ds_write_b64 v10, v[58:59] offset:288
  ds_write_b64 v10, v[60:61] offset:432
  s_mov_b64 exec, -1
  v_lshlrev_b32 v16, 16, v98
  v_and_b32 v17, 0xffff0000, v98
  v_lshlrev_b32 v18, 16, v102
  v_and_b32 v19, 0xffff0000, v102
  v_lshlrev_b32 v20, 16, v106
  v_and_b32 v21, 0xffff0000, v106
  v_lshlrev_b32 v22, 16, v110
  v_and_b32 v23, 0xffff0000, v110
  v_lshlrev_b32 v24, 16, v114
  v_and_b32 v25, 0xffff0000, v114
  v_lshlrev_b32 v26, 16, v118
  v_and_b32 v27, 0xffff0000, v118
  v_lshlrev_b32 v28, 16, v122
  v_and_b32 v29, 0xffff0000, v122
  v_lshlrev_b32 v30, 16, v152
  v_and_b32 v32, 0xffff0000, v152
  v_lshlrev_b32 v34, 16, v153
  v_and_b32 v36, 0xffff0000, v153
  v_lshlrev_b32 v31, 16, v154
  v_and_b32 v33, 0xffff0000, v154
  v_lshlrev_b32 v35, 16, v155
  v_and_b32 v37, 0xffff0000, v155
  v_lshlrev_b32 v38, 16, v126
  v_and_b32 v39, 0xffff0000, v126
  v_lshlrev_b32 v40, 16, v130
  v_and_b32 v41, 0xffff0000, v130
  v_lshlrev_b32 v42, 16, v134
  v_and_b32 v43, 0xffff0000, v134
  v_lshlrev_b32 v44, 16, v138
  v_and_b32 v45, 0xffff0000, v138
  v_pk_mul_f32 v[46:47], v[16:17], v[36:37]
  v_pk_mul_f32 v[48:49], v[18:19], v[36:37]
  v_pk_mul_f32 v[50:51], v[20:21], v[36:37]
  v_pk_mul_f32 v[52:53], v[22:23], v[36:37]
  v_pk_fma_f32 v[46:47], v[18:19], v[34:35], v[46:47]
  v_pk_fma_f32 v[48:49], v[20:21], v[34:35], v[48:49]
  v_pk_fma_f32 v[50:51], v[22:23], v[34:35], v[50:51]
  v_pk_fma_f32 v[52:53], v[24:25], v[34:35], v[52:53]
  v_pk_fma_f32 v[46:47], v[20:21], v[32:33], v[46:47]
  v_pk_fma_f32 v[48:49], v[22:23], v[32:33], v[48:49]
  v_pk_fma_f32 v[50:51], v[24:25], v[32:33], v[50:51]
  v_pk_fma_f32 v[52:53], v[26:27], v[32:33], v[52:53]
  v_pk_fma_f32 v[46:47], v[22:23], v[30:31], v[46:47]
  v_pk_fma_f32 v[48:49], v[24:25], v[30:31], v[48:49]
  v_pk_fma_f32 v[50:51], v[26:27], v[30:31], v[50:51]
  v_pk_fma_f32 v[52:53], v[28:29], v[30:31], v[52:53]
  v_pk_mul_f32 v[46:47], v[46:47], v[38:39]
  v_pk_mul_f32 v[48:49], v[48:49], v[40:41]
  v_pk_mul_f32 v[50:51], v[50:51], v[42:43]
  v_pk_mul_f32 v[52:53], v[52:53], v[44:45]
  v_cvt_pk_bf16_f32 v54, v52, v50
  v_cvt_pk_bf16_f32 v55, v48, v46
  v_cvt_pk_bf16_f32 v56, v53, v51
  v_cvt_pk_bf16_f32 v57, v49, v47
  s_mov_b64 exec, s[92:93]
  ds_write_b64 v10, v[54:55] offset:576
  ds_write_b64 v10, v[56:57] offset:720
  s_mov_b64 exec, -1
  v_lshlrev_b32 v16, 16, v99
  v_and_b32 v17, 0xffff0000, v99
  v_lshlrev_b32 v18, 16, v103
  v_and_b32 v19, 0xffff0000, v103
  v_lshlrev_b32 v20, 16, v107
  v_and_b32 v21, 0xffff0000, v107
  v_lshlrev_b32 v22, 16, v111
  v_and_b32 v23, 0xffff0000, v111
  v_lshlrev_b32 v24, 16, v115
  v_and_b32 v25, 0xffff0000, v115
  v_lshlrev_b32 v26, 16, v119
  v_and_b32 v27, 0xffff0000, v119
  v_lshlrev_b32 v28, 16, v123
  v_and_b32 v29, 0xffff0000, v123
  v_lshlrev_b32 v30, 16, v156
  v_and_b32 v32, 0xffff0000, v156
  v_lshlrev_b32 v34, 16, v157
  v_and_b32 v36, 0xffff0000, v157
  v_lshlrev_b32 v31, 16, v158
  v_and_b32 v33, 0xffff0000, v158
  v_lshlrev_b32 v35, 16, v159
  v_and_b32 v37, 0xffff0000, v159
  v_lshlrev_b32 v38, 16, v127
  v_and_b32 v39, 0xffff0000, v127
  v_lshlrev_b32 v40, 16, v131
  v_and_b32 v41, 0xffff0000, v131
  v_lshlrev_b32 v42, 16, v135
  v_and_b32 v43, 0xffff0000, v135
  v_lshlrev_b32 v44, 16, v139
  v_and_b32 v45, 0xffff0000, v139
  v_pk_mul_f32 v[46:47], v[16:17], v[36:37]
  v_pk_mul_f32 v[48:49], v[18:19], v[36:37]
  v_pk_mul_f32 v[50:51], v[20:21], v[36:37]
  v_pk_mul_f32 v[52:53], v[22:23], v[36:37]
  v_pk_fma_f32 v[46:47], v[18:19], v[34:35], v[46:47]
  v_pk_fma_f32 v[48:49], v[20:21], v[34:35], v[48:49]
  v_pk_fma_f32 v[50:51], v[22:23], v[34:35], v[50:51]
  v_pk_fma_f32 v[52:53], v[24:25], v[34:35], v[52:53]
  v_pk_fma_f32 v[46:47], v[20:21], v[32:33], v[46:47]
  v_pk_fma_f32 v[48:49], v[22:23], v[32:33], v[48:49]
  v_pk_fma_f32 v[50:51], v[24:25], v[32:33], v[50:51]
  v_pk_fma_f32 v[52:53], v[26:27], v[32:33], v[52:53]
  v_pk_fma_f32 v[46:47], v[22:23], v[30:31], v[46:47]
  v_pk_fma_f32 v[48:49], v[24:25], v[30:31], v[48:49]
  v_pk_fma_f32 v[50:51], v[26:27], v[30:31], v[50:51]
  v_pk_fma_f32 v[52:53], v[28:29], v[30:31], v[52:53]
  v_pk_mul_f32 v[46:47], v[46:47], v[38:39]
  v_pk_mul_f32 v[48:49], v[48:49], v[40:41]
  v_pk_mul_f32 v[50:51], v[50:51], v[42:43]
  v_pk_mul_f32 v[52:53], v[52:53], v[44:45]
  v_cvt_pk_bf16_f32 v58, v52, v50
  v_cvt_pk_bf16_f32 v59, v48, v46
  v_cvt_pk_bf16_f32 v60, v53, v51
  v_cvt_pk_bf16_f32 v61, v49, v47
  s_mov_b64 exec, s[92:93]
  ds_write_b64 v10, v[58:59] offset:864
  ds_write_b64 v10, v[60:61] offset:1008
  s_mov_b64 exec, -1
  v_lshrrev_b32 v8, 6, v0
  v_mul_u32_u24 v8, 1168, v8
  v_bfe_u32 v9, v0, 3, 3
  v_mul_u32_u24 v9, 144, v9
  v_and_b32 v11, 7, v0
  v_lshlrev_b32 v11, 4, v11
  v_add3_u32 v8, v8, v9, v11
  v_add_u32 v8, 0, v8
  s_mul_i32 s80, s28, 327680
  s_lshl_b32 s81, s29, 7
  s_sub_u32 s80, s80, s81
  s_add_u32 s80, s80, 0x1e00f80
  v_lshrrev_b32 v9, 3, v0
  v_lshlrev_b32 v9, 12, v9
  v_add3_u32 v52, v9, v11, s80
  v_add_u32 v53, 131072, v52
  v_add_u32 v54, 262144, v52
  s_waitcnt lgkmcnt(0)
  s_barrier
  ds_read_b128 v[40:43], v8
  ds_read_b128 v[44:47], v8 offset:4672
  ds_read_b128 v[48:51], v8 offset:9344
  s_waitcnt lgkmcnt(0)
  global_store_dwordx4 v52, v[40:43], s[26:27]
  global_store_dwordx4 v53, v[44:47], s[26:27]
  s_cmp_ge_u32 s30, 2
  s_cbranch_scc1 L_c0s_2
  global_store_dwordx4 v54, v[48:51], s[26:27]
L_c0s_2:
  s_mov_b64 s[92:93], s[6:7]
  s_mov_b32 s36, s6
  s_mov_b32 s37, s7
  s_mov_b32 s38, 2457600
  s_mov_b32 s39, 0x00020000
  s_mov_b32 exec_lo, 0x77777777
  s_mov_b32 exec_hi, 0x7777777
  s_mov_b32 s47, 0
  buffer_load_dwordx4 a[0:3], v90, s[36:39], s47 offen
  s_add_u32 s47, s47, 19200
  buffer_load_dwordx4 a[4:7], v90, s[36:39], s47 offen
  s_add_u32 s47, s47, 19200
  buffer_load_dwordx4 a[8:11], v90, s[36:39], s47 offen
  s_add_u32 s47, s47, 19200
  buffer_load_dwordx4 a[12:15], v90, s[36:39], s47 offen
  s_add_u32 s47, s47, 19200
  buffer_load_dwordx4 a[16:19], v90, s[36:39], s47 offen
  s_add_u32 s47, s47, 19200
  buffer_load_dwordx4 a[20:23], v90, s[36:39], s47 offen
  s_mov_b64 exec, -1
  s_waitcnt vmcnt(6)
  s_barrier
  s_cmp_lg_u32 s30, 0
  s_cbranch_scc1 L_f0_3
  s_add_u32 s46, s31, 7
  v_mov_b32 v5, s46
  s_lshl_b32 s44, s28, 12
  s_add_u32 s44, s44, 0x70000
  s_add_u32 s44, s44, s26
  s_addc_u32 s45, s27, 0
  s_mov_b32 exec_lo, 0x1
  s_mov_b32 exec_hi, 0x0
  global_store_dword v6, v5, s[44:45]
  s_mov_b64 exec, -1
L_f0_3:
  s_lshl_b32 s48, s33, 3
  s_add_u32 s48, s48, s28
  s_mul_i32 s45, s28, 327680
  s_add_u32 s66, s26, 0x100000
  s_addc_u32 s67, s27, 0
  s_add_u32 s66, s66, s45
  s_addc_u32 s67, s67, 0
  s_add_u32 s68, s26, 0x1400000
  s_addc_u32 s69, s27, 0
  s_add_u32 s68, s68, s45
  s_addc_u32 s69, s69, 0
  s_add_u32 s70, s26, 0x1900000
  s_addc_u32 s71, s27, 0
  s_add_u32 s70, s70, s45
  s_addc_u32 s71, s71, 0
  s_mov_b64 s[76:77], s[66:67]
  s_lshl_b32 s46, s48, 5
  s_add_u32 s46, s46, s29
  s_lshl_b32 s78, s46, 7
  s_add_u32 s78, s78, 0x14000
  s_sub_u32 s79, s78, 4096
  s_mul_i32 s46, s46, 28672
  s_add_u32 s72, s26, 0x5ec000
  s_addc_u32 s73, s27, 0
  s_add_u32 s72, s72, s46
  s_addc_u32 s73, s73, 0
  s_sub_u32 s46, s46, 917504
  s_cmp_eq_u32 s28, 0
  s_cselect_b32 s46, 0, s46
  s_add_u32 s74, s26, 0x600000
  s_addc_u32 s75, s27, 0
  s_add_u32 s74, s74, s46
  s_addc_u32 s75, s75, 0
  s_mul_i32 s44, s33, 3
  s_add_u32 s44, s44, 0
  s_lshl_b32 s44, s44, 3
  s_add_u32 s44, s44, s28
  s_lshl_b32 s44, s44, 12
  s_add_u32 s56, s26, 0x40000
  s_addc_u32 s57, s27, 0
  s_add_u32 s56, s56, s44
  s_addc_u32 s57, s57, 0
  s_add_u32 s58, s56, 32768
  s_addc_u32 s59, s57, 0
  s_add_u32 s60, s58, 32768
  s_addc_u32 s61, s59, 0
  s_add_u32 s62, s60, 32768
  s_addc_u32 s63, s61, 0
  s_mul_i32 s34, s33, 3
  s_add_u32 s34, s34, s31
  s_add_u32 s34, s34, 1
  s_add_u32 s35, s31, s33
  s_add_u32 s35, s35, 16
  s_mov_b32 s36, s6
  s_mov_b32 s37, s7
  s_mov_b32 s38, 2457600
  s_mov_b32 s39, 0x00020000
  v_and_b32 v8, 127, v0
  v_lshlrev_b32 v9, 4, v8
  v_add_u32 v11, s88, v9
  ds_write_b128 v11, v[92:95] offset:21760
  v_and_b32 v16, 63, v8
  v_lshlrev_b32 v16, 4, v16
  v_add_u32 v16, s88, v16
  ds_write_b128 v16, v[92:95] offset:23808
  v_add_u32 v11, 64, v11
  v_lshrrev_b32 v70, 2, v8
  v_add_u32 v70, v70, v8
  v_lshlrev_b32 v70, 4, v70
  v_add_u32 v70, s88, v70
  v_alignbit_b32 v132, v169, v168, 16
  v_alignbit_b32 v133, v170, v169, 16
  v_alignbit_b32 v134, v171, v170, 16
  v_alignbit_b32 v135, v172, v171, 16
  v_mov_b32 v136, v133
  v_mov_b32 v137, v134
  v_mov_b32 v138, v135
  v_alignbit_b32 v139, v173, v172, 16
  v_mov_b32 v112, v169
  v_mov_b32 v113, v170
  v_mov_b32 v114, v171
  v_mov_b32 v115, v172
  ds_write_b128 v11, v[132:135] offset:0
  ds_write_b128 v11, v[112:115] offset:4160
  ds_write_b128 v11, v[136:139] offset:8320
  ds_write_b128 v11, v[170:173] offset:12480
  v_alignbit_b32 v132, v177, v176, 16
  s_mov_b32 s47, 115200
  s_mov_b32 exec_lo, 0x77777777
  s_mov_b32 exec_hi, 0x7777777
  buffer_load_dwordx4 a[24:27], v90, s[36:39], s47 offen
  s_mov_b64 exec, -1
  v_alignbit_b32 v133, v178, v177, 16
  v_alignbit_b32 v134, v179, v178, 16
  v_alignbit_b32 v135, v180, v179, 16
  v_mov_b32 v136, v133
  v_mov_b32 v137, v134
  v_mov_b32 v138, v135
  v_alignbit_b32 v139, v181, v180, 16
  v_mov_b32 v116, v177
  v_mov_b32 v117, v178
  v_mov_b32 v118, v179
  v_mov_b32 v119, v180
  ds_write_b128 v11, v[132:135] offset:2048
  ds_write_b128 v11, v[116:119] offset:6208
  ds_write_b128 v11, v[136:139] offset:10368
  ds_write_b128 v11, v[178:181] offset:14528
  v_min_u32 v16, 191, v0
  v_lshlrev_b32 v16, 4, v16
  v_add_u32 v16, 135168, v16
  ds_write_b128 v16, v[92:95] offset:21760
  v_lshlrev_b32 v11, 4, v0
  v_add_u32 v11, 135232, v11
  v_lshrrev_b32 v71, 2, v0
  v_add_u32 v71, v71, v0
  v_lshlrev_b32 v71, 4, v71
  v_add_u32 v71, 135168, v71
  v_alignbit_b32 v132, v189, v188, 16
  v_alignbit_b32 v133, v190, v189, 16
  v_alignbit_b32 v134, v191, v190, 16
  v_alignbit_b32 v135, v192, v191, 16
  v_mov_b32 v136, v133
  s_mov_b32 s47, 134400
  s_mov_b32 exec_lo, 0x77777777
  s_mov_b32 exec_hi, 0x7777777
  buffer_load_dwordx4 a[28:31], v90, s[36:39], s47 offen
  s_mov_b64 exec, -1
  v_mov_b32 v137, v134
  v_mov_b32 v138, v135
  v_alignbit_b32 v139, v193, v192, 16
  v_mov_b32 v120, v189
  v_mov_b32 v121, v190
  v_mov_b32 v122, v191
  v_mov_b32 v123, v192
  ds_write_b128 v11, v[132:135] offset:0
  ds_write_b128 v11, v[120:123] offset:4160
  ds_write_b128 v11, v[136:139] offset:8320
  ds_write_b128 v11, v[190:193] offset:12480
  s_cmp_lg_u32 s90, 0
  s_cbranch_scc1 L_hd_200004
  v_readlane_b32 s50, v168, 0
  v_readlane_b32 s51, v169, 0
  v_readfirstlane_b32 s52, v186
  s_and_b32 s53, s89, 1
  s_lshl_b32 s53, s53, 4
  s_lshr_b32 s52, s52, s53
  s_lshl_b32 s52, s52, 16
  s_lshl_b32 s53, s50, 16
  v_mov_b32 v16, s52
  v_add_f32 v16, s53, v16
  v_cvt_pk_bf16_f32 v16, v16, v16
  v_and_b32 v16, 0xffff, v16
  s_and_b32 s50, s50, 0xffff0000
  v_or_b32 v16, s50, v16
  v_mov_b32 v17, s51
  v_lshrrev_b32 v18, 2, v1
  v_sub_u32 v19, 3, v18
  v_lshlrev_b32 v19, 4, v19
  v_and_b32 v19, 63, v19
  v_lshlrev_b64 v[26:27], v19, v[16:17]
  v_and_b32 v19, 3, v1
  v_cmp_eq_u32 vcc, 3, v19
  v_mov_b32 v24, 0
  v_mov_b32 v25, 0
  v_cndmask_b32 v26, 0, v26, vcc
  v_cndmask_b32 v27, 0, v27, vcc
  v_mul_u32_u24 v18, 4160, v18
  v_lshl_add_u32 v18, v19, 4, v18
  v_add_u32 v18, s88, v18
  s_mov_b32 exec_lo, 0xffff
  s_mov_b32 exec_hi, 0x0
  ds_write_b128 v18, v[24:27]
  s_mov_b64 exec, -1
L_hd_200004:
  s_mov_b32 s47, 153600
  s_mov_b32 exec_lo, 0x77777777
  s_mov_b32 exec_hi, 0x7777777
  buffer_load_dwordx4 a[32:35], v90, s[36:39], s47 offen
  s_mov_b64 exec, -1
  s_cmp_lg_u32 s30, 0
  s_cbranch_scc1 L_hd_200005
  s_mov_b32 s54, 135168
  v_readlane_b32 s50, v188, 0
  v_readlane_b32 s51, v189, 0
  v_readfirstlane_b32 s52, v194
  s_and_b32 s53, s91, 1
  s_lshl_b32 s53, s53, 4
  s_lshr_b32 s52, s52, s53
  s_lshl_b32 s52, s52, 16
  s_lshl_b32 s53, s50, 16
  v_mov_b32 v16, s52
  v_add_f32 v16, s53, v16
  v_cvt_pk_bf16_f32 v16, v16, v16
  v_and_b32 v16, 0xffff, v16
  s_and_b32 s50, s50, 0xffff0000
  v_or_b32 v16, s50, v16
  v_mov_b32 v17, s51
  v_lshrrev_b32 v18, 2, v1
  v_sub_u32 v19, 3, v18
  v_lshlrev_b32 v19, 4, v19
  v_and_b32 v19, 63, v19
  v_lshlrev_b64 v[26:27], v19, v[16:17]
  v_and_b32 v19, 3, v1
  v_cmp_eq_u32 vcc, 3, v19
  v_mov_b32 v24, 0
  v_mov_b32 v25, 0
  v_cndmask_b32 v26, 0, v26, vcc
  v_cndmask_b32 v27, 0, v27, vcc
  v_mul_u32_u24 v18, 4160, v18
  v_lshl_add_u32 v18, v19, 4, v18
  v_add_u32 v18, s54, v18
  s_mov_b32 exec_lo, 0xffff
  s_mov_b32 exec_hi, 0x0
  ds_write_b128 v18, v[24:27]
  s_mov_b64 exec, -1
L_hd_200005:
  s_mov_b32 s47, 172800
  s_mov_b32 exec_lo, 0x77777777
  s_mov_b32 exec_hi, 0x7777777
  buffer_load_dwordx4 a[36:39], v90, s[36:39], s47 offen
  s_mov_b64 exec, -1
  v_lshlrev_b32 v10, 6, v0
  v_add_u32 v10, 40968, v10
  ds_write_b64 v10, v[92:93]
  ds_write_b64 v10, v[92:93] offset:16384
  s_cmp_ge_u32 s30, 2
  s_cbranch_scc1 L_wz_200006
  ds_write_b64 v10, v[92:93] offset:32768
L_wz_200006:
  s_lshl_b32 s48, s30, 2
  s_mov_b32 s40, 0xf
  s_mov_b32 s41, 0
  s_lshl_b64 s[40:41], s[40:41], s48
  s_sub_u32 s48, 28, s48
  s_mov_b32 s4, 0xf
  s_mov_b32 s5, 0
  s_lshl_b64 s[4:5], s[4:5], s48
  s_or_b64 s[4:5], s[4:5], s[40:41]
  s_lshr_b32 s48, s29, 3
  s_lshl_b32 s48, s48, 3
  s_mov_b32 s10, 0xff
  s_mov_b32 s11, 0
  s_lshl_b64 s[10:11], s[10:11], s48
  s_lshl_b32 s49, s90, 5
  v_and_b32 v10, 3, v1
  v_mul_u32_u24 v10, 4160, v10
  v_bfe_u32 v11, v1, 2, 3
  v_lshl_add_u32 v10, v11, 3, v10
  v_lshrrev_b32 v11, 5, v1
  v_lshl_add_u32 v10, v11, 4, v10
  s_lshl_b32 s50, s49, 5
  s_add_u32 s50, s50, s88
  s_mov_b32 s47, 192000
  s_mov_b32 exec_lo, 0x77777777
  s_mov_b32 exec_hi, 0x7777777
  buffer_load_dwordx4 a[40:43], v90, s[36:39], s47 offen
  s_mov_b64 exec, -1
  v_add_u32 v74, s50, v10
  v_and_b32 v10, 31, v1
  v_sub_u32 v10, 31, v10
  v_mul_u32_u24 v10, 5, v10
  v_add_u32 v10, v10, v11
  v_lshlrev_b32 v10, 4, v10
  s_mul_i32 s50, s49, 40
  s_add_u32 s50, s50, s88
  s_add_u32 s50, s50, 16640
  v_add_u32 v75, s50, v10
  s_mov_b32 s54, 135168
  s_lshl_b32 s49, s30, 4
  v_and_b32 v10, 3, v1
  v_mul_u32_u24 v10, 4160, v10
  v_bfe_u32 v11, v1, 2, 3
  v_lshl_add_u32 v10, v11, 3, v10
  v_lshrrev_b32 v11, 5, v1
  v_lshl_add_u32 v10, v11, 4, v10
  s_lshl_b32 s50, s49, 5
  s_add_u32 s50, s50, s54
  v_add_u32 v76, s50, v10
  v_and_b32 v10, 31, v1
  v_sub_u32 v10, 31, v10
  v_mul_u32_u24 v10, 5, v10
  v_add_u32 v10, v10, v11
  v_lshlrev_b32 v10, 4, v10
  s_mul_i32 s50, s49, 40
  s_add_u32 s50, s50, s54
  s_add_u32 s50, s50, 16640
  v_add_u32 v77, s50, v10
  s_mov_b32 s47, 211200
  s_mov_b32 exec_lo, 0x77777777
  s_mov_b32 exec_hi, 0x7777777
  buffer_load_dwordx4 a[44:47], v90, s[36:39], s47 offen
  s_mov_b64 exec, -1
  s_and_b32 s44, s29, 7
  s_mul_i32 s44, s44, 160
  v_min_u32 v4, 49, v1
  v_mul_u32_u24 v5, 6554, v4
  v_lshrrev_b32 v5, 16, v5
  v_mul_u32_u24 v78, 10, v5
  v_sub_u32 v4, v4, v78
  s_mul_i32 s45, s30, 80
  v_add_u32 v5, s45, v5
  v_mul_u32_u24 v78, 1280, v5
  v_lshl_add_u32 v78, v4, 4, v78
  v_add_u32 v78, s44, v78
  s_mov_b32 s6, -1
  s_mov_b32 s7, 0
  s_lshl_b32 s44, s28, 12
  s_add_u32 s45, s44, 0x1000
  s_add_u32 s44, s44, 0x70000
  v_mov_b32 v16, s45
  v_mov_b32 v17, s44
  s_mov_b32 s42, 0
  s_mov_b32 s43, -1
  v_cndmask_b32 v16, v16, v17, s[42:43]
  v_add_u32 v16, v16, v15
  s_add_u32 s46, s31, 64
  s_add_u32 s47, s31, 7
  v_mov_b32 v17, s46
  v_mov_b32 v18, s47
  v_cndmask_b32 v17, v17, v18, s[42:43]
  v_mov_b32 v18, 16
  v_cndmask_b32 v18, v18, 1, s[42:43]
L_xpoll_200007:
  global_load_dword v5, v16, s[26:27] sc1
  s_cmp_eq_u32 s64, 0
  s_cbranch_scc1 L_xpolld_200008
  s_sub_u32 s64, s64, 1
  s_waitcnt vmcnt(0)
  v_sub_u32 v5, v5, v17
  v_cmp_le_u32 vcc, v18, v5
  s_nop 0
  s_cmp_lg_u32 vcc_lo, 0
  s_cbranch_scc1 L_xpoll_200007
  s_mov_b32 s48, vcc_hi
  v_cmp_ne_u32 vcc, s65, v5
  s_nop 0
  s_cmp_lg_u32 vcc_lo, 0
  s_cbranch_scc1 L_xpolld_200008
  s_cmp_lg_u32 s48, 0
  s_cbranch_scc1 L_xpoll_200007
L_xpolld_200008:
  v_cmp_ne_u32 vcc, s65, v5
  s_nop 0
  s_cmp_lg_u32 vcc_lo, 0
  s_cselect_b32 s32, 1, 0
  s_cmp_lg_u32 s32, 0
  s_cbranch_scc1 L_slowr_200009
L_slowrj_200010:
  s_lshl_b32 s47, s89, 12
  s_add_u32 s47, s47, 0x1e00000
  v_and_b32 v4, 127, v0
  v_lshl_add_u32 v4, v4, 4, s47
  global_load_dwordx4 v[196:199], v4, s[26:27] sc1
  global_load_dwordx4 v[200:203], v4, s[26:27] offset:2048 sc1
  s_lshl_b32 s47, s91, 12
  s_add_u32 s47, s47, 0x1e00000
  v_lshl_add_u32 v4, v0, 4, s47
  global_load_dwordx4 v[204:207], v4, s[26:27] sc1
  s_lshr_b32 s44, s29, 2
  s_mul_i32 s44, s44, 40960
  s_and_b32 s45, s29, 3
  s_lshl_b32 s45, s45, 7
  s_add_u32 s44, s44, s45
  s_lshl_b32 s45, s30, 5
  s_add_u32 s44, s44, s45
  v_lshrrev_b32 v8, 1, v1
  v_lshlrev_b32 v8, 9, v8
  v_and_b32 v9, 1, v1
  v_lshlrev_b32 v9, 4, v9
  v_add3_u32 v8, v8, v9, s44
  v_add_u32 v9, 16384, v8
  v_add_u32 v10, 32768, v8
  v_lshlrev_b32 v16, 16, v232
  v_and_b32 v17, 0xffff0000, v232
  v_lshlrev_b32 v18, 16, v233
  v_and_b32 v19, 0xffff0000, v233
  v_lshlrev_b32 v20, 16, v234
  v_and_b32 v21, 0xffff0000, v234
  v_lshlrev_b32 v22, 16, v235
  v_and_b32 v23, 0xffff0000, v235
  v_lshlrev_b32 v24, 16, v236
  v_and_b32 v25, 0xffff0000, v236
  v_lshlrev_b32 v26, 16, v237
  v_and_b32 v27, 0xffff0000, v237
  v_lshlrev_b32 v28, 16, v238
  v_and_b32 v29, 0xffff0000, v238
  v_lshlrev_b32 v30, 16, v239
  v_and_b32 v31, 0xffff0000, v239
  v_lshlrev_b32 v32, 16, v240
  v_and_b32 v33, 0xffff0000, v240
  v_lshlrev_b32 v34, 16, v241
  v_and_b32 v35, 0xffff0000, v241
  v_lshlrev_b32 v36, 16, v242
  v_and_b32 v37, 0xffff0000, v242
  v_lshlrev_b32 v38, 16, v243
  v_and_b32 v39, 0xffff0000, v243
  v_pk_add_f32 v[44:45], v[16:17], v[18:19]
  v_pk_mul_f32 v[46:47], v[16:17], v[16:17]
  v_pk_fma_f32 v[46:47], v[18:19], v[18:19], v[46:47]
  v_pk_add_f32 v[44:45], v[44:45], v[20:21]
  v_pk_fma_f32 v[46:47], v[20:21], v[20:21], v[46:47]
  v_pk_add_f32 v[44:45], v[44:45], v[22:23]
  v_pk_fma_f32 v[46:47], v[22:23], v[22:23], v[46:47]
  v_pk_add_f32 v[44:45], v[44:45], v[24:25]
  v_pk_fma_f32 v[46:47], v[24:25], v[24:25], v[46:47]
  v_pk_add_f32 v[44:45], v[44:45], v[26:27]
  v_pk_fma_f32 v[46:47], v[26:27], v[26:27], v[46:47]
  v_pk_add_f32 v[44:45], v[44:45], v[28:29]
  v_pk_fma_f32 v[46:47], v[28:29], v[28:29], v[46:47]
  v_pk_add_f32 v[44:45], v[44:45], v[30:31]
  v_pk_fma_f32 v[46:47], v[30:31], v[30:31], v[46:47]
  v_pk_add_f32 v[44:45], v[44:45], v[32:33]
  v_pk_fma_f32 v[46:47], v[32:33], v[32:33], v[46:47]
  v_pk_add_f32 v[44:45], v[44:45], v[34:35]
  v_pk_fma_f32 v[46:47], v[34:35], v[34:35], v[46:47]
  v_pk_add_f32 v[44:45], v[44:45], v[36:37]
  v_pk_fma_f32 v[46:47], v[36:37], v[36:37], v[46:47]
  v_pk_add_f32 v[44:45], v[44:45], v[38:39]
  v_pk_fma_f32 v[46:47], v[38:39], v[38:39], v[46:47]
  v_add_f32 v44, v44, v45
  v_add_f32 v46, v46, v47
  s_nop 0
  v_add_f32_dpp v44, v44, v44 quad_perm:[2,3,0,1] row_mask:0xf bank_mask:0xf
  v_add_f32_dpp v46, v46, v46 quad_perm:[2,3,0,1] row_mask:0xf bank_mask:0xf
  s_nop 0
  v_add_f32_dpp v44, v44, v44 row_ror:4 row_mask:0xf bank_mask:0xf
  v_add_f32_dpp v46, v46, v46 row_ror:4 row_mask:0xf bank_mask:0xf
  s_nop 0
  v_add_f32_dpp v44, v44, v44 row_ror:8 row_mask:0xf bank_mask:0xf
  v_add_f32_dpp v46, v46, v46 row_ror:8 row_mask:0xf bank_mask:0xf
  s_nop 1
  v_permlane16_swap_b32 v44, v46
  v_add_f32 v44, v44, v46
  v_mov_b32 v48, v44
  s_nop 1
  v_permlane32_swap_b32 v44, v48
  v_add_f32 v44, v44, v48
  v_mov_b32 v46, v44
  s_nop 1
  v_permlane16_swap_b32 v44, v46
  v_mul_f32 v44, 0x3acccccd, v44
  v_mul_f32 v46, 0x3acccccd, v46
  v_fma_f32 v46, -v44, v44, v46
  v_max_f32 v46, 0, v46
  v_cvt_pk_bf16_f32 v48, v44, v44
  v_and_b32 v44, 0xffff0000, v48
  v_cvt_pk_bf16_f32 v50, v46, v46
  v_and_b32 v46, 0xffff0000, v50
  v_add_f32 v46, 0x3727c5ac, v46
  v_cvt_pk_bf16_f32 v50, v46, v46
  v_and_b32 v46, 0xffff0000, v50
  v_sqrt_f32 v46, v46
  s_nop 0
  v_cvt_pk_bf16_f32 v50, v46, v46
  v_and_b32 v46, 0xffff0000, v50
  v_rcp_f32 v40, v46
  s_nop 0
  v_mov_b32 v41, v40
  v_mul_f32 v42, v44, v40
  v_sub_f32 v42, 0, v42
  v_mov_b32 v43, v42
  v_pk_fma_f32 v[16:17], v[16:17], v[40:41], v[42:43]
  v_pk_fma_f32 v[18:19], v[18:19], v[40:41], v[42:43]
  v_pk_fma_f32 v[20:21], v[20:21], v[40:41], v[42:43]
  v_pk_fma_f32 v[22:23], v[22:23], v[40:41], v[42:43]
  v_pk_fma_f32 v[24:25], v[24:25], v[40:41], v[42:43]
  v_pk_fma_f32 v[26:27], v[26:27], v[40:41], v[42:43]
  v_pk_fma_f32 v[28:29], v[28:29], v[40:41], v[42:43]
  v_pk_fma_f32 v[30:31], v[30:31], v[40:41], v[42:43]
  v_pk_fma_f32 v[32:33], v[32:33], v[40:41], v[42:43]
  v_pk_fma_f32 v[34:35], v[34:35], v[40:41], v[42:43]
  v_pk_fma_f32 v[36:37], v[36:37], v[40:41], v[42:43]
  v_pk_fma_f32 v[38:39], v[38:39], v[40:41], v[42:43]
  v_cvt_pk_bf16_f32 v56, v16, v17
  v_cvt_pk_bf16_f32 v57, v18, v19
  v_cvt_pk_bf16_f32 v58, v20, v21
  v_cvt_pk_bf16_f32 v59, v22, v23
  v_cvt_pk_bf16_f32 v60, v24, v25
  v_cvt_pk_bf16_f32 v61, v26, v27
  v_cvt_pk_bf16_f32 v62, v28, v29
  v_cvt_pk_bf16_f32 v63, v30, v31
  v_cvt_pk_bf16_f32 v64, v32, v33
  v_cvt_pk_bf16_f32 v65, v34, v35
  v_cvt_pk_bf16_f32 v66, v36, v37
  v_cvt_pk_bf16_f32 v67, v38, v39
  s_cmp_lg_u32 s32, 0
  s_cbranch_scc1 L_slow_200011
  global_store_dwordx4 v8, v[56:59], s[66:67]
  global_store_dwordx4 v9, v[60:63], s[66:67]
  s_mov_b32 exec_lo, 0xffffffff
  s_mov_b32 exec_hi, 0x0
  global_store_dwordx4 v10, v[64:67], s[66:67]
  s_mov_b64 exec, -1
L_stj_200012:
  s_mov_b32 s36, s92
  s_mov_b32 s37, s93
  s_mov_b32 s38, 2457600
  s_mov_b32 s39, 0x00020000
  s_mov_b32 s47, 230400
  s_mov_b32 exec_lo, 0x77777777
  s_mov_b32 exec_hi, 0x7777777
  buffer_load_dwordx4 a[48:51], v90, s[36:39], s47 offen
  s_mov_b64 exec, -1
  s_mov_b32 s47, 249600
  s_mov_b32 exec_lo, 0x77777777
  s_mov_b32 exec_hi, 0x7777777
  buffer_load_dwordx4 a[52:55], v90, s[36:39], s47 offen
  s_mov_b64 exec, -1
  s_mov_b32 s47, 268800
  s_mov_b32 exec_lo, 0x77777777
  s_mov_b32 exec_hi, 0x7777777
  buffer_load_dwordx4 a[56:59], v90, s[36:39], s47 offen
  s_mov_b64 exec, -1
  s_mov_b32 s47, 288000
  s_mov_b32 exec_lo, 0x77777777
  s_mov_b32 exec_hi, 0x7777777
  buffer_load_dwordx4 a[60:63], v90, s[36:39], s47 offen
  s_mov_b64 exec, -1
  v_lshlrev_b32 v5, 7, v0
  v_min_u32 v5, L_HOTEND-L_PC-4, v5
  global_load_dword v86, v5, s[100:101]
  v_min_u32 v4, 5, v1
  v_lshlrev_b32 v4, 15, v4
  s_lshl_b32 s44, s28, 12
  s_lshl_b32 s45, s29, 7
  s_add_u32 s44, s44, s45
  s_add_u32 s44, s44, 0x40000
  v_add_u32 v4, s44, v4
  global_load_dword v84, v4, s[26:27]
  s_mov_b32 exec_lo, 0x33333333
  s_mov_b32 exec_hi, 0x3333333
  ds_write_b128 v91, a[0:3] offset:0
  ds_write_b128 v91, a[4:7] offset:320
  ds_write_b128 v91, a[8:11] offset:640
  ds_write_b128 v91, a[12:15] offset:960
  ds_write_b128 v91, a[16:19] offset:1280
  ds_write_b128 v91, a[20:23] offset:1600
  ds_write_b128 v91, a[24:27] offset:1920
  ds_write_b128 v91, a[28:31] offset:2240
  ds_write_b128 v91, a[32:35] offset:2560
  ds_write_b128 v91, a[36:39] offset:2880
  ds_write_b128 v91, a[40:43] offset:3200
  ds_write_b128 v91, a[44:47] offset:3520
  s_mov_b32 exec_lo, 0x44444444
  s_mov_b32 exec_hi, 0x4444444
  ds_write_b64 v91, a[0:1] offset:0
  ds_write_b64 v91, a[4:5] offset:320
  ds_write_b64 v91, a[8:9] offset:640
  ds_write_b64 v91, a[12:13] offset:960
  ds_write_b64 v91, a[16:17] offset:1280
  ds_write_b64 v91, a[20:21] offset:1600
  ds_write_b64 v91, a[24:25] offset:1920
  ds_write_b64 v91, a[28:29] offset:2240
  ds_write_b64 v91, a[32:33] offset:2560
  ds_write_b64 v91, a[36:37] offset:2880
  ds_write_b64 v91, a[40:41] offset:3200
  ds_write_b64 v91, a[44:45] offset:3520
  s_mov_b64 exec, -1
  s_waitcnt vmcnt(10)
  ds_write_b128 v70, v[196:199] offset:16640
  ds_write_b128 v70, v[200:203] offset:19200
  s_waitcnt vmcnt(9)
  ds_write_b128 v71, v[204:207] offset:16640
  s_waitcnt lgkmcnt(0)
  s_barrier
  s_waitcnt vmcnt(2)
  s_mov_b32 exec_lo, 0x33333333
  s_mov_b32 exec_hi, 0x3333333
  ds_write_b128 v91, a[48:51] offset:3840
  ds_write_b128 v91, a[52:55] offset:4160
  ds_write_b128 v91, a[56:59] offset:4480
  ds_write_b128 v91, a[60:63] offset:4800
  s_mov_b32 exec_lo, 0x44444444
  s_mov_b32 exec_hi, 0x4444444
  ds_write_b64 v91, a[48:49] offset:3840
  ds_write_b64 v91, a[52:53] offset:4160
  ds_write_b64 v91, a[56:57] offset:4480
  ds_write_b64 v91, a[60:61] offset:4800
  s_mov_b64 exec, -1
  s_waitcnt lgkmcnt(0)
  s_barrier
  v_mov_b32 v4, s34
  s_cmp_lg_u32 s30, 0
  s_cbranch_scc1 L_sig_200013
  s_mov_b32 exec_lo, 0x1
  s_mov_b32 exec_hi, 0x0
  s_cmp_lg_u32 s32, 0
  s_cbranch_scc1 L_slow_200014
  global_store_dword v6, v4, s[56:57]
L_stj_200015:
  s_mov_b64 exec, -1
L_sig_200013:
  v_mfma_f32_32x32x16_bf16 v[16:31], v[92:95], v[92:95], 0
  v_mfma_f32_32x32x16_bf16 v[32:47], v[92:95], v[92:95], 0
  v_mfma_f32_32x32x16_bf16 v[48:63], v[92:95], v[92:95], 0
  s_mov_b32 s42, 0x77777777
  s_mov_b32 s43, 0x7777777
  s_mov_b32 s36, s92
  s_mov_b32 s37, s93
  s_mov_b32 s38, 2457600
  s_mov_b32 s39, 0x00020000
  ds_read_b64 v[96:97], v74 offset:0
  ds_read_b64 v[98:99], v74 offset:8
  ds_read_b128 v[104:107], v75 offset:2560
  ds_read_b128 v[108:111], v75 offset:0
  ds_read_b64 v[100:101], v74 offset:2048
  ds_read_b64 v[102:103], v74 offset:2056
  ds_read_b64 v[112:113], v74 offset:32
  ds_read_b64 v[114:115], v74 offset:40
  ds_read_b128 v[120:123], v75 offset:2592
  ds_read_b128 v[124:127], v75 offset:32
  ds_read_b64 v[116:117], v74 offset:2080
  ds_read_b64 v[118:119], v74 offset:2088
  s_waitcnt lgkmcnt(6)
  v_mfma_f32_32x32x16_bf16 v[16:31], v[96:99], v[104:107], v[16:31]
  ds_read_b64 v[128:129], v74 offset:64
  ds_read_b64 v[130:131], v74 offset:72
  v_mfma_f32_32x32x16_bf16 v[32:47], v[96:99], v[108:111], v[32:47]
  ds_read_b128 v[136:139], v75 offset:2640
  ds_read_b128 v[140:143], v75 offset:80
  s_lshl_b32 s44, s30, 11
  s_add_u32 s44, s44, 110592
  v_and_b32 v4, 31, v1
  v_bfe_u32 v5, v4, 1, 3
  v_lshlrev_b32 v4, 6, v4
  v_mfma_f32_32x32x16_bf16 v[32:47], v[100:103], v[104:107], v[32:47]
  ds_read_b64 v[132:133], v74 offset:2112
  ds_read_b64 v[134:135], v74 offset:2120
  s_mov_b32 s47, 307200
  s_mov_b64 exec, s[42:43]
  buffer_load_dwordx4 a[0:3], v90, s[36:39], s47 offen
  s_mov_b64 exec, -1
  s_waitcnt lgkmcnt(6)
  v_mfma_f32_32x32x16_bf16 v[16:31], v[112:115], v[120:123], v[16:31]
  ds_read_b64 v[144:145], v74 offset:96
  ds_read_b64 v[146:147], v74 offset:104
  v_mfma_f32_32x32x16_bf16 v[32:47], v[112:115], v[124:127], v[32:47]
  ds_read_b128 v[152:155], v75 offset:2672
  ds_read_b128 v[156:159], v75 offset:112
  v_add_u32 v4, s44, v4
  v_lshrrev_b32 v224, 5, v1
  v_xor_b32 v224, v224, v5
  v_lshl_add_u32 v224, v224, 3, v4
  v_xor_b32 v225, 16, v224
  v_mfma_f32_32x32x16_bf16 v[32:47], v[116:119], v[120:123], v[32:47]
  ds_read_b64 v[148:149], v74 offset:2144
  ds_read_b64 v[150:151], v74 offset:2152
  s_mov_b32 s47, 326400
  s_mov_b64 exec, s[42:43]
  buffer_load_dwordx4 a[4:7], v90, s[36:39], s47 offen
  s_mov_b64 exec, -1
  s_waitcnt lgkmcnt(6)
  v_mfma_f32_32x32x16_bf16 v[16:31], v[128:131], v[136:139], v[16:31]
  ds_read_b64 v[96:97], v74 offset:128
  ds_read_b64 v[98:99], v74 offset:136
  v_mfma_f32_32x32x16_bf16 v[32:47], v[128:131], v[140:143], v[32:47]
  ds_read_b128 v[104:107], v75 offset:2720
  ds_read_b128 v[108:111], v75 offset:160
  v_xor_b32 v226, 40, v224
  v_xor_b32 v4, 48, v224
  v_mov_b32 v88, 0x3f80
  v_mov_b32 v89, 0
  v_bfe_u32 v4, v1, 2, 2
  v_mfma_f32_32x32x16_bf16 v[32:47], v[132:135], v[136:139], v[32:47]
  ds_read_b64 v[100:101], v74 offset:2176
  ds_read_b64 v[102:103], v74 offset:2184
  s_mov_b32 s47, 345600
  s_mov_b64 exec, s[42:43]
  buffer_load_dwordx4 a[8:11], v90, s[36:39], s47 offen
  s_mov_b64 exec, -1
  s_waitcnt lgkmcnt(6)
  v_mfma_f32_32x32x16_bf16 v[16:31], v[144:147], v[152:155], v[16:31]
  ds_read_b64 v[112:113], v74 offset:160
  ds_read_b64 v[114:115], v74 offset:168
  v_mfma_f32_32x32x16_bf16 v[32:47], v[144:147], v[156:159], v[32:47]
  ds_read_b128 v[120:123], v75 offset:2752
  ds_read_b128 v[124:127], v75 offset:192
  v_lshrrev_b32 v5, 5, v1
  v_lshl_add_u32 v4, v5, 2, v4
  v_bfe_u32 v5, v1, 4, 1
  v_lshlrev_b32 v5, 2, v5
  v_and_b32 v227, 3, v1
  v_mfma_f32_32x32x16_bf16 v[32:47], v[148:151], v[152:155], v[32:47]
  ds_read_b64 v[116:117], v74 offset:2208
  ds_read_b64 v[118:119], v74 offset:2216
  s_mov_b32 s47, 364800
  s_mov_b64 exec, s[42:43]
  buffer_load_dwordx4 a[12:15], v90, s[36:39], s47 offen
  s_mov_b64 exec, -1
  s_waitcnt lgkmcnt(6)
  v_mfma_f32_32x32x16_bf16 v[16:31], v[96:99], v[104:107], v[16:31]
  ds_read_b64 v[128:129], v74 offset:192
  ds_read_b64 v[130:131], v74 offset:200
  v_mfma_f32_32x32x16_bf16 v[32:47], v[96:99], v[108:111], v[32:47]
  ds_read_b128 v[136:139], v75 offset:2800
  ds_read_b128 v[140:143], v75 offset:240
  v_add_u32 v5, v5, v227
  v_lshrrev_b32 v227, 1, v4
  v_xor_b32 v5, v5, v227
  v_lshlrev_b32 v5, 3, v5
  v_lshl_add_u32 v227, v4, 6, v5
  v_mfma_f32_32x32x16_bf16 v[32:47], v[100:103], v[104:107], v[32:47]
  ds_read_b64 v[132:133], v74 offset:2240
  ds_read_b64 v[134:135], v74 offset:2248
  s_mov_b32 s47, 384000
  s_mov_b64 exec, s[42:43]
  buffer_load_dwordx4 a[16:19], v90, s[36:39], s47 offen
  s_mov_b64 exec, -1
  s_waitcnt lgkmcnt(6)
  v_mfma_f32_32x32x16_bf16 v[16:31], v[112:115], v[120:123], v[16:31]
  ds_read_b64 v[144:145], v74 offset:224
  ds_read_b64 v[146:147], v74 offset:232
  v_mfma_f32_32x32x16_bf16 v[32:47], v[112:115], v[124:127], v[32:47]
  ds_read_b128 v[152:155], v75 offset:2832
  ds_read_b128 v[156:159], v75 offset:272
  v_add_u32 v227, s44, v227
  v_xor_b32 v228, 32, v227
  s_mov_b32 s45, s30
  s_mul_i32 s46, s45, 1536
  s_add_u32 s46, s46, 81920
  v_mfma_f32_32x32x16_bf16 v[32:47], v[116:119], v[120:123], v[32:47]
  ds_read_b64 v[148:149], v74 offset:2272
  ds_read_b64 v[150:151], v74 offset:2280
  s_mov_b32 s47, 403200
  s_mov_b64 exec, s[42:43]
  buffer_load_dwordx4 a[20:23], v90, s[36:39], s47 offen
  s_mov_b64 exec, -1
  s_waitcnt lgkmcnt(6)
  v_mfma_f32_32x32x16_bf16 v[16:31], v[128:131], v[136:139], v[16:31]
  ds_read_b64 v[96:97], v74 offset:256
  ds_read_b64 v[98:99], v74 offset:264
  v_mfma_f32_32x32x16_bf16 v[32:47], v[128:131], v[140:143], v[32:47]
  ds_read_b128 v[104:107], v75 offset:2880
  ds_read_b128 v[108:111], v75 offset:320
  v_add_u32 v229, s46, v2
  s_add_u32 s46, s46, 1024
  v_add_u32 v230, s46, v3
  s_lshl_b32 s46, s45, 11
  s_add_u32 s46, s46, 94208
  v_mfma_f32_32x32x16_bf16 v[32:47], v[132:135], v[136:139], v[32:47]
  ds_read_b64 v[100:101], v74 offset:2304
  ds_read_b64 v[102:103], v74 offset:2312
  s_mov_b32 s47, 422400
  s_mov_b64 exec, s[42:43]
  buffer_load_dwordx4 a[24:27], v90, s[36:39], s47 offen
  s_mov_b64 exec, -1
  s_waitcnt lgkmcnt(6)
  v_mfma_f32_32x32x16_bf16 v[16:31], v[144:147], v[152:155], v[16:31]
  ds_read_b64 v[112:113], v74 offset:288
  ds_read_b64 v[114:115], v74 offset:296
  v_mfma_f32_32x32x16_bf16 v[32:47], v[144:147], v[156:159], v[32:47]
  ds_read_b128 v[120:123], v75 offset:2912
  ds_read_b128 v[124:127], v75 offset:352
  v_add_u32 v231, s46, v2
  s_sub_u32 s45, 7, s30
  s_mul_i32 s46, s45, 1536
  s_add_u32 s46, s46, 81920
  v_add_u32 v12, s46, v2
  v_mfma_f32_32x32x16_bf16 v[32:47], v[148:151], v[152:155], v[32:47]
  ds_read_b64 v[116:117], v74 offset:2336
  ds_read_b64 v[118:119], v74 offset:2344
  s_mov_b32 s47, 441600
  s_mov_b64 exec, s[42:43]
  buffer_load_dwordx4 a[28:31], v90, s[36:39], s47 offen
  s_mov_b64 exec, -1
  s_waitcnt lgkmcnt(6)
  v_mfma_f32_32x32x16_bf16 v[16:31], v[96:99], v[104:107], v[16:31]
  ds_read_b64 v[128:129], v74 offset:320
  ds_read_b64 v[130:131], v74 offset:328
  v_mfma_f32_32x32x16_bf16 v[32:47], v[96:99], v[108:111], v[32:47]
  ds_read_b128 v[136:139], v75 offset:2960
  ds_read_b128 v[140:143], v75 offset:400
  s_add_u32 s46, s46, 1024
  v_add_u32 v13, s46, v3
  s_lshl_b32 s46, s45, 11
  s_add_u32 s46, s46, 94208
  v_add_u32 v14, s46, v2
  v_mfma_f32_32x32x16_bf16 v[32:47], v[100:103], v[104:107], v[32:47]
  ds_read_b64 v[132:133], v74 offset:2368
  ds_read_b64 v[134:135], v74 offset:2376
  s_mov_b32 s47, 460800
  s_mov_b64 exec, s[42:43]
  buffer_load_dwordx4 a[32:35], v90, s[36:39], s47 offen
  s_mov_b64 exec, -1
  s_waitcnt lgkmcnt(6)
  v_mfma_f32_32x32x16_bf16 v[16:31], v[112:115], v[120:123], v[16:31]
  ds_read_b64 v[144:145], v74 offset:352
  ds_read_b64 v[146:147], v74 offset:360
  v_mfma_f32_32x32x16_bf16 v[32:47], v[112:115], v[124:127], v[32:47]
  ds_read_b128 v[152:155], v75 offset:2992
  ds_read_b128 v[156:159], v75 offset:432
  s_mov_b32 s94, 0x3ea52b5c
  s_mov_b32 s95, s94
  s_mul_i32 s44, s30, 40960
  v_add_u32 v8, s44, v2
  s_sub_u32 s45, 7, s30
  v_mfma_f32_32x32x16_bf16 v[32:47], v[116:119], v[120:123], v[32:47]
  ds_read_b64 v[148:149], v74 offset:2400
  ds_read_b64 v[150:151], v74 offset:2408
  s_mov_b32 s47, 480000
  s_mov_b64 exec, s[42:43]
  buffer_load_dwordx4 a[36:39], v90, s[36:39], s47 offen
  s_mov_b64 exec, -1
  s_waitcnt lgkmcnt(6)
  v_mfma_f32_32x32x16_bf16 v[16:31], v[128:131], v[136:139], v[16:31]
  ds_read_b64 v[96:97], v74 offset:384
  ds_read_b64 v[98:99], v74 offset:392
  v_mfma_f32_32x32x16_bf16 v[32:47], v[128:131], v[140:143], v[32:47]
  ds_read_b128 v[104:107], v75 offset:3040
  ds_read_b128 v[108:111], v75 offset:480
  s_mul_i32 s45, s45, 40960
  v_add_u32 v9, s45, v2
  v_lshrrev_b32 v4, 5, v1
  v_lshlrev_b32 v4, 3, v4
  v_bfe_u32 v5, v1, 2, 2
  v_mfma_f32_32x32x16_bf16 v[32:47], v[132:135], v[136:139], v[32:47]
  ds_read_b64 v[100:101], v74 offset:2432
  ds_read_b64 v[102:103], v74 offset:2440
  s_mov_b32 s47, 499200
  s_mov_b64 exec, s[42:43]
  buffer_load_dwordx4 a[40:43], v90, s[36:39], s47 offen
  s_mov_b64 exec, -1
  s_waitcnt lgkmcnt(6)
  v_mfma_f32_32x32x16_bf16 v[16:31], v[144:147], v[152:155], v[16:31]
  ds_read_b64 v[112:113], v74 offset:416
  ds_read_b64 v[114:115], v74 offset:424
  v_mfma_f32_32x32x16_bf16 v[32:47], v[144:147], v[156:159], v[32:47]
  ds_read_b128 v[120:123], v75 offset:3072
  ds_read_b128 v[124:127], v75 offset:512
  v_add_u32 v4, v4, v5
  v_lshlrev_b32 v4, 6, v4
  v_bfe_u32 v5, v1, 4, 1
  v_lshlrev_b32 v5, 5, v5
  v_and_b32 v10, 3, v1
  v_mfma_f32_32x32x16_bf16 v[32:47], v[148:151], v[152:155], v[32:47]
  ds_read_b64 v[116:117], v74 offset:2464
  ds_read_b64 v[118:119], v74 offset:2472
  s_mov_b32 s47, 518400
  s_mov_b64 exec, s[42:43]
  buffer_load_dwordx4 a[44:47], v90, s[36:39], s47 offen
  s_mov_b64 exec, -1
  s_waitcnt lgkmcnt(6)
  v_mfma_f32_32x32x16_bf16 v[16:31], v[96:99], v[104:107], v[16:31]
  ds_read_b64 v[128:129], v74 offset:448
  ds_read_b64 v[130:131], v74 offset:456
  v_mfma_f32_32x32x16_bf16 v[32:47], v[96:99], v[108:111], v[32:47]
  ds_read_b128 v[136:139], v75 offset:3120
  ds_read_b128 v[140:143], v75 offset:560
  v_lshlrev_b32 v10, 3, v10
  v_add3_u32 v10, v4, v5, v10
  v_add_u32 v11, 40960, v10
  v_and_b32 v4, 31, v1
  v_lshrrev_b32 v5, 5, v1
  v_mfma_f32_32x32x16_bf16 v[32:47], v[100:103], v[104:107], v[32:47]
  ds_read_b64 v[132:133], v74 offset:2496
  ds_read_b64 v[134:135], v74 offset:2504
  s_mov_b32 s47, 537600
  s_mov_b64 exec, s[42:43]
  buffer_load_dwordx4 a[48:51], v90, s[36:39], s47 offen
  s_mov_b64 exec, -1
  s_waitcnt lgkmcnt(6)
  v_mfma_f32_32x32x16_bf16 v[16:31], v[112:115], v[120:123], v[16:31]
  ds_read_b64 v[144:145], v74 offset:480
  ds_read_b64 v[146:147], v74 offset:488
  v_mfma_f32_32x32x16_bf16 v[32:47], v[112:115], v[124:127], v[32:47]
  ds_read_b128 v[152:155], v75 offset:3152
  ds_read_b128 v[156:159], v75 offset:592
  v_lshlrev_b32 v5, 2, v5
  v_sub_u32 v4, v4, v5
  v_mov_b32 v5, 0xf149f2ca
  v_cmp_le_i32 s[80:81], 0, v4
  v_cmp_le_i32 s[82:83], 1, v4
  v_mfma_f32_32x32x16_bf16 v[32:47], v[116:119], v[120:123], v[32:47]
  ds_read_b64 v[148:149], v74 offset:2528
  ds_read_b64 v[150:151], v74 offset:2536
  s_mov_b32 s47, 556800
  s_mov_b64 exec, s[42:43]
  buffer_load_dwordx4 a[52:55], v90, s[36:39], s47 offen
  s_mov_b64 exec, -1
  s_waitcnt lgkmcnt(6)
  v_mfma_f32_32x32x16_bf16 v[16:31], v[128:131], v[136:139], v[16:31]
  ds_read_b64 v[96:97], v74 offset:512
  ds_read_b64 v[98:99], v74 offset:520
  v_mfma_f32_32x32x16_bf16 v[32:47], v[128:131], v[140:143], v[32:47]
  ds_read_b128 v[104:107], v75 offset:3200
  ds_read_b128 v[108:111], v75 offset:640
  v_cndmask_b32 v208, v5, 0, s[80:81]
  v_cmp_le_i32 s[84:85], 2, v4
  v_cndmask_b32 v209, v5, 0, s[82:83]
  v_cmp_le_i32 s[86:87], 3, v4
  v_cndmask_b32 v210, v5, 0, s[84:85]
  v_mfma_f32_32x32x16_bf16 v[32:47], v[132:135], v[136:139], v[32:47]
  ds_read_b64 v[100:101], v74 offset:2560
  ds_read_b64 v[102:103], v74 offset:2568
  s_mov_b32 s47, 576000
  s_mov_b64 exec, s[42:43]
  buffer_load_dwordx4 a[56:59], v90, s[36:39], s47 offen
  s_mov_b64 exec, -1
  s_waitcnt lgkmcnt(6)
  v_mfma_f32_32x32x16_bf16 v[16:31], v[144:147], v[152:155], v[16:31]
  ds_read_b64 v[112:113], v74 offset:544
  ds_read_b64 v[114:115], v74 offset:552
  v_mfma_f32_32x32x16_bf16 v[32:47], v[144:147], v[156:159], v[32:47]
  ds_read_b128 v[120:123], v75 offset:3232
  ds_read_b128 v[124:127], v75 offset:672
  v_cmp_le_i32 s[80:81], 8, v4
  v_cndmask_b32 v211, v5, 0, s[86:87]
  v_cmp_le_i32 s[82:83], 9, v4
  v_cndmask_b32 v212, v5, 0, s[80:81]
  v_cmp_le_i32 s[84:85], 10, v4
  v_mfma_f32_32x32x16_bf16 v[32:47], v[148:151], v[152:155], v[32:47]
  ds_read_b64 v[116:117], v74 offset:2592
  ds_read_b64 v[118:119], v74 offset:2600
  s_mov_b32 s47, 595200
  s_mov_b64 exec, s[42:43]
  buffer_load_dwordx4 a[60:63], v90, s[36:39], s47 offen
  s_mov_b64 exec, -1
  s_waitcnt lgkmcnt(6)
  v_mfma_f32_32x32x16_bf16 v[16:31], v[96:99], v[104:107], v[16:31]
  ds_read_b64 v[128:129], v74 offset:576
  ds_read_b64 v[130:131], v74 offset:584
  v_mfma_f32_32x32x16_bf16 v[32:47], v[96:99], v[108:111], v[32:47]
  ds_read_b128 v[136:139], v75 offset:3280
  ds_read_b128 v[140:143], v75 offset:720
  v_cndmask_b32 v213, v5, 0, s[82:83]
  v_cmp_le_i32 s[86:87], 11, v4
  v_cndmask_b32 v214, v5, 0, s[84:85]
  v_cmp_le_i32 s[80:81], 16, v4
  v_cndmask_b32 v215, v5, 0, s[86:87]
  v_mfma_f32_32x32x16_bf16 v[32:47], v[100:103], v[104:107], v[32:47]
  ds_read_b64 v[132:133], v74 offset:2624
  ds_read_b64 v[134:135], v74 offset:2632
  s_mov_b32 s36, s8
  s_mov_b32 s37, s9
  s_mov_b32 s38, 819200
  s_mov_b32 s39, 0x00020000
  s_mov_b32 s51, 0
  buffer_load_dwordx4 a[64:67], v78, s[36:39], s51 offen
  s_waitcnt lgkmcnt(6)
  v_mfma_f32_32x32x16_bf16 v[16:31], v[112:115], v[120:123], v[16:31]
  ds_read_b64 v[144:145], v74 offset:608
  ds_read_b64 v[146:147], v74 offset:616
  v_mfma_f32_32x32x16_bf16 v[32:47], v[112:115], v[124:127], v[32:47]
  ds_read_b128 v[152:155], v75 offset:3312
  ds_read_b128 v[156:159], v75 offset:752
  v_cmp_le_i32 s[82:83], 17, v4
  v_cndmask_b32 v216, v5, 0, s[80:81]
  v_cmp_le_i32 s[84:85], 18, v4
  v_cndmask_b32 v217, v5, 0, s[82:83]
  v_cmp_le_i32 s[86:87], 19, v4
  v_mfma_f32_32x32x16_bf16 v[32:47], v[116:119], v[120:123], v[32:47]
  ds_read_b64 v[148:149], v74 offset:2656
  ds_read_b64 v[150:151], v74 offset:2664
  s_mov_b32 s51, 6400
  buffer_load_dwordx4 a[68:71], v78, s[36:39], s51 offen
  s_waitcnt lgkmcnt(6)
  v_mfma_f32_32x32x16_bf16 v[16:31], v[128:131], v[136:139], v[16:31]
  ds_read_b64 v[96:97], v74 offset:640
  ds_read_b64 v[98:99], v74 offset:648
  v_mfma_f32_32x32x16_bf16 v[32:47], v[128:131], v[140:143], v[32:47]
  ds_read_b128 v[104:107], v75 offset:3360
  ds_read_b128 v[108:111], v75 offset:800
  v_cndmask_b32 v218, v5, 0, s[84:85]
  v_cmp_le_i32 s[80:81], 24, v4
  v_cndmask_b32 v219, v5, 0, s[86:87]
  v_cmp_le_i32 s[82:83], 25, v4
  v_cndmask_b32 v220, v5, 0, s[80:81]
  v_mfma_f32_32x32x16_bf16 v[32:47], v[132:135], v[136:139], v[32:47]
  ds_read_b64 v[100:101], v74 offset:2688
  ds_read_b64 v[102:103], v74 offset:2696
  s_mov_b32 s51, 12800
  buffer_load_dwordx4 a[72:75], v78, s[36:39], s51 offen
  s_waitcnt lgkmcnt(6)
  v_mfma_f32_32x32x16_bf16 v[16:31], v[144:147], v[152:155], v[16:31]
  ds_read_b64 v[112:113], v74 offset:672
  ds_read_b64 v[114:115], v74 offset:680
  v_mfma_f32_32x32x16_bf16 v[32:47], v[144:147], v[156:159], v[32:47]
  ds_read_b128 v[120:123], v75 offset:3392
  ds_read_b128 v[124:127], v75 offset:832
  v_cmp_le_i32 s[84:85], 26, v4
  v_cndmask_b32 v221, v5, 0, s[82:83]
  v_cmp_le_i32 s[86:87], 27, v4
  v_cndmask_b32 v222, v5, 0, s[84:85]
  s_nop 0
  v_cndmask_b32 v223, v5, 0, s[86:87]
  v_mfma_f32_32x32x16_bf16 v[32:47], v[148:151], v[152:155], v[32:47]
  ds_read_b64 v[116:117], v74 offset:2720
  ds_read_b64 v[118:119], v74 offset:2728
  s_mov_b32 s51, 19200
  buffer_load_dwordx4 a[76:79], v78, s[36:39], s51 offen
  s_waitcnt lgkmcnt(6)
  v_mfma_f32_32x32x16_bf16 v[16:31], v[96:99], v[104:107], v[16:31]
  ds_read_b64 v[128:129], v74 offset:704
  ds_read_b64 v[130:131], v74 offset:712
  v_mfma_f32_32x32x16_bf16 v[32:47], v[96:99], v[108:111], v[32:47]
  ds_read_b128 v[136:139], v75 offset:3440
  ds_read_b128 v[140:143], v75 offset:880
  s_lshl_b32 s52, s30, 12
  v_add_u32 v64, s52, v2
  s_xor_b32 s53, s30, 1
  s_lshl_b32 s53, s53, 12
  s_add_u32 s53, s53, 81920
  v_mfma_f32_32x32x16_bf16 v[32:47], v[100:103], v[104:107], v[32:47]
  ds_read_b64 v[132:133], v74 offset:2752
  ds_read_b64 v[134:135], v74 offset:2760
  s_mov_b32 s51, 25600
  buffer_load_dwordx4 a[80:83], v78, s[36:39], s51 offen
  s_waitcnt lgkmcnt(6)
  v_mfma_f32_32x32x16_bf16 v[16:31], v[112:115], v[120:123], v[16:31]
  ds_read_b64 v[144:145], v74 offset:736
  ds_read_b64 v[146:147], v74 offset:744
  v_mfma_f32_32x32x16_bf16 v[32:47], v[112:115], v[124:127], v[32:47]
  ds_read_b128 v[152:155], v75 offset:3472
  ds_read_b128 v[156:159], v75 offset:912
  v_add_u32 v67, s53, v2
  v_add_u32 v66, 81920, v64
  v_add_u32 v65, 106752, v64
  s_lshl_b32 s52, s30, 10
  s_add_u32 s52, s52, 106752
  v_mfma_f32_32x32x16_bf16 v[32:47], v[116:119], v[120:123], v[32:47]
  ds_read_b64 v[148:149], v74 offset:2784
  ds_read_b64 v[150:151], v74 offset:2792
  s_mov_b32 s51, 32000
  buffer_load_dwordx4 a[84:87], v78, s[36:39], s51 offen
  s_waitcnt lgkmcnt(6)
  v_mfma_f32_32x32x16_bf16 v[16:31], v[128:131], v[136:139], v[16:31]
  ds_read_b64 v[96:97], v74 offset:768
  ds_read_b64 v[98:99], v74 offset:776
  v_mfma_f32_32x32x16_bf16 v[32:47], v[128:131], v[140:143], v[32:47]
  ds_read_b128 v[104:107], v75 offset:3520
  ds_read_b128 v[108:111], v75 offset:960
  v_add_u32 v64, s52, v2
  v_and_b32 v70, 31, v1
  v_lshlrev_b32 v70, 6, v70
  v_lshrrev_b32 v71, 5, v1
  v_lshl_add_u32 v70, v71, 3, v70
  v_mfma_f32_32x32x16_bf16 v[32:47], v[132:135], v[136:139], v[32:47]
  ds_read_b64 v[100:101], v74 offset:2816
  ds_read_b64 v[102:103], v74 offset:2824
  s_mov_b32 s51, 38400
  buffer_load_dwordx4 a[88:91], v78, s[36:39], s51 offen
  s_waitcnt lgkmcnt(6)
  v_mfma_f32_32x32x16_bf16 v[16:31], v[144:147], v[152:155], v[16:31]
  ds_read_b64 v[112:113], v74 offset:800
  ds_read_b64 v[114:115], v74 offset:808
  v_mfma_f32_32x32x16_bf16 v[32:47], v[144:147], v[156:159], v[32:47]
  ds_read_b128 v[120:123], v75 offset:3552
  ds_read_b128 v[124:127], v75 offset:992
  s_lshl_b32 s52, s30, 11
  s_add_u32 s52, s52, 135168
  v_add_u32 v71, s52, v70
  v_add_u32 v72, s52, v2
  s_lshl_b32 s52, s30, 4
  v_mfma_f32_32x32x16_bf16 v[32:47], v[148:151], v[152:155], v[32:47]
  ds_read_b64 v[116:117], v74 offset:2848
  ds_read_b64 v[118:119], v74 offset:2856
  s_mov_b32 s51, 44800
  buffer_load_dwordx4 a[92:95], v78, s[36:39], s51 offen
  s_waitcnt lgkmcnt(6)
  v_mfma_f32_32x32x16_bf16 v[16:31], v[96:99], v[104:107], v[16:31]
  ds_read_b64 v[128:129], v74 offset:832
  ds_read_b64 v[130:131], v74 offset:840
  v_mfma_f32_32x32x16_bf16 v[32:47], v[96:99], v[108:111], v[32:47]
  ds_read_b128 v[136:139], v75 offset:3600
  ds_read_b128 v[140:143], v75 offset:1040
  s_add_u32 s52, s52, 143360
  v_add_u32 v70, s52, v70
  s_lshl_b32 s52, s90, 11
  s_lshl_b32 s53, s89, 12
  s_add_u32 s52, s52, s53
  v_mfma_f32_32x32x16_bf16 v[32:47], v[100:103], v[104:107], v[32:47]
  ds_read_b64 v[132:133], v74 offset:2880
  ds_read_b64 v[134:135], v74 offset:2888
  s_mov_b32 s51, 51200
  buffer_load_dwordx4 a[96:99], v78, s[36:39], s51 offen
  s_waitcnt lgkmcnt(6)
  v_mfma_f32_32x32x16_bf16 v[16:31], v[112:115], v[120:123], v[16:31]
  ds_read_b64 v[144:145], v74 offset:864
  ds_read_b64 v[146:147], v74 offset:872
  v_mfma_f32_32x32x16_bf16 v[32:47], v[112:115], v[124:127], v[32:47]
  ds_read_b128 v[152:155], v75 offset:3632
  ds_read_b128 v[156:159], v75 offset:1072
  s_add_u32 s52, s52, 0x2100000
  v_add_u32 v73, s52, v2
  v_mfma_f32_32x32x16_bf16 v[32:47], v[116:119], v[120:123], v[32:47]
  ds_read_b64 v[148:149], v74 offset:2912
  ds_read_b64 v[150:151], v74 offset:2920
  s_mov_b32 s51, 57600
  buffer_load_dwordx4 a[100:103], v78, s[36:39], s51 offen
  s_waitcnt lgkmcnt(6)
  v_mfma_f32_32x32x16_bf16 v[16:31], v[128:131], v[136:139], v[16:31]
  ds_read_b64 v[96:97], v74 offset:896
  ds_read_b64 v[98:99], v74 offset:904
  v_mfma_f32_32x32x16_bf16 v[32:47], v[128:131], v[140:143], v[32:47]
  ds_read_b128 v[104:107], v75 offset:3680
  ds_read_b128 v[108:111], v75 offset:1120
  v_mfma_f32_32x32x16_bf16 v[32:47], v[132:135], v[136:139], v[32:47]
  ds_read_b64 v[100:101], v74 offset:2944
  ds_read_b64 v[102:103], v74 offset:2952
  s_mov_b32 s51, 64000
  buffer_load_dwordx4 a[104:107], v78, s[36:39], s51 offen
  s_waitcnt lgkmcnt(6)
  v_mfma_f32_32x32x16_bf16 v[16:31], v[144:147], v[152:155], v[16:31]
  ds_read_b64 v[112:113], v74 offset:928
  ds_read_b64 v[114:115], v74 offset:936
  v_mfma_f32_32x32x16_bf16 v[32:47], v[144:147], v[156:159], v[32:47]
  ds_read_b128 v[120:123], v75 offset:3712
  ds_read_b128 v[124:127], v75 offset:1152
  v_mfma_f32_32x32x16_bf16 v[32:47], v[148:151], v[152:155], v[32:47]
  ds_read_b64 v[116:117], v74 offset:2976
  ds_read_b64 v[118:119], v74 offset:2984
  s_mov_b32 s51, 70400
  buffer_load_dwordx4 a[108:111], v78, s[36:39], s51 offen
  s_waitcnt lgkmcnt(6)
  v_mfma_f32_32x32x16_bf16 v[16:31], v[96:99], v[104:107], v[16:31]
  ds_read_b64 v[128:129], v74 offset:960
  ds_read_b64 v[130:131], v74 offset:968
  v_mfma_f32_32x32x16_bf16 v[32:47], v[96:99], v[108:111], v[32:47]
  ds_read_b128 v[136:139], v75 offset:3760
  ds_read_b128 v[140:143], v75 offset:1200
  v_mfma_f32_32x32x16_bf16 v[32:47], v[100:103], v[104:107], v[32:47]
  ds_read_b64 v[132:133], v74 offset:3008
  ds_read_b64 v[134:135], v74 offset:3016
  s_mov_b32 s51, 76800
  buffer_load_dwordx4 a[112:115], v78, s[36:39], s51 offen
  s_waitcnt lgkmcnt(6)
  v_mfma_f32_32x32x16_bf16 v[16:31], v[112:115], v[120:123], v[16:31]
  ds_read_b64 v[144:145], v74 offset:992
  ds_read_b64 v[146:147], v74 offset:1000
  v_mfma_f32_32x32x16_bf16 v[32:47], v[112:115], v[124:127], v[32:47]
  ds_read_b128 v[152:155], v75 offset:3792
  ds_read_b128 v[156:159], v75 offset:1232
  v_mfma_f32_32x32x16_bf16 v[32:47], v[116:119], v[120:123], v[32:47]
  ds_read_b64 v[148:149], v74 offset:3040
  ds_read_b64 v[150:151], v74 offset:3048
  s_mov_b32 s51, 83200
  buffer_load_dwordx4 a[116:119], v78, s[36:39], s51 offen
  s_waitcnt lgkmcnt(6)
  v_mfma_f32_32x32x16_bf16 v[16:31], v[128:131], v[136:139], v[16:31]
  v_mfma_f32_32x32x16_bf16 v[32:47], v[128:131], v[140:143], v[32:47]
  v_mfma_f32_32x32x16_bf16 v[32:47], v[132:135], v[136:139], v[32:47]
  s_mov_b32 s51, 89600
  buffer_load_dwordx4 a[120:123], v78, s[36:39], s51 offen
  s_waitcnt lgkmcnt(0)
  v_mfma_f32_32x32x16_bf16 v[16:31], v[144:147], v[152:155], v[16:31]
  v_mfma_f32_32x32x16_bf16 v[32:47], v[144:147], v[156:159], v[32:47]
  v_mfma_f32_32x32x16_bf16 v[32:47], v[148:151], v[152:155], v[32:47]
  s_mov_b32 s51, 96000
  buffer_load_dwordx4 a[124:127], v78, s[36:39], s51 offen
  s_and_b32 s49, s29, 1
  s_cbranch_scc1 L_c2hi_300016
  ds_read_b64 v[96:97], v76 offset:0
  ds_read_b64 v[98:99], v76 offset:8
  ds_read_b128 v[104:107], v77 offset:2560
  ds_read_b64 v[112:113], v76 offset:32
  ds_read_b64 v[114:115], v76 offset:40
  ds_read_b128 v[120:123], v77 offset:2592
  s_waitcnt lgkmcnt(3)
  v_mfma_f32_32x32x16_bf16 v[48:63], v[96:99], v[104:107], v[48:63]
  ds_read_b64 v[128:129], v76 offset:64
  ds_read_b64 v[130:131], v76 offset:72
  ds_read_b128 v[136:139], v77 offset:2640
  s_mov_b32 s51, 409600
  buffer_load_dwordx4 a[128:131], v78, s[36:39], s51 offen
  s_waitcnt lgkmcnt(3)
  v_mfma_f32_32x32x16_bf16 v[48:63], v[112:115], v[120:123], v[48:63]
  ds_read_b64 v[144:145], v76 offset:96
  ds_read_b64 v[146:147], v76 offset:104
  ds_read_b128 v[152:155], v77 offset:2672
  s_mov_b32 s51, 416000
  buffer_load_dwordx4 a[132:135], v78, s[36:39], s51 offen
  s_waitcnt lgkmcnt(3)
  v_mfma_f32_32x32x16_bf16 v[48:63], v[128:131], v[136:139], v[48:63]
  ds_read_b64 v[96:97], v76 offset:128
  ds_read_b64 v[98:99], v76 offset:136
  ds_read_b128 v[104:107], v77 offset:2720
  s_mov_b32 s51, 422400
  buffer_load_dwordx4 a[136:139], v78, s[36:39], s51 offen
  s_waitcnt lgkmcnt(3)
  v_mfma_f32_32x32x16_bf16 v[48:63], v[144:147], v[152:155], v[48:63]
  ds_read_b64 v[112:113], v76 offset:160
  ds_read_b64 v[114:115], v76 offset:168
  ds_read_b128 v[120:123], v77 offset:2752
  s_mov_b32 s51, 428800
  buffer_load_dwordx4 a[140:143], v78, s[36:39], s51 offen
  s_waitcnt lgkmcnt(3)
  v_mfma_f32_32x32x16_bf16 v[48:63], v[96:99], v[104:107], v[48:63]
  ds_read_b64 v[128:129], v76 offset:192
  ds_read_b64 v[130:131], v76 offset:200
  ds_read_b128 v[136:139], v77 offset:2800
  s_mov_b32 s51, 435200
  buffer_load_dwordx4 a[144:147], v78, s[36:39], s51 offen
  s_waitcnt lgkmcnt(3)
  v_mfma_f32_32x32x16_bf16 v[48:63], v[112:115], v[120:123], v[48:63]
  ds_read_b64 v[144:145], v76 offset:224
  ds_read_b64 v[146:147], v76 offset:232
  ds_read_b128 v[152:155], v77 offset:2832
  s_mov_b32 s51, 441600
  buffer_load_dwordx4 a[148:151], v78, s[36:39], s51 offen
  s_waitcnt lgkmcnt(3)
  v_mfma_f32_32x32x16_bf16 v[48:63], v[128:131], v[136:139], v[48:63]
  ds_read_b64 v[96:97], v76 offset:256
  ds_read_b64 v[98:99], v76 offset:264
  ds_read_b128 v[104:107], v77 offset:2880
  s_mov_b32 s51, 448000
  buffer_load_dwordx4 a[152:155], v78, s[36:39], s51 offen
  s_waitcnt lgkmcnt(3)
  v_mfma_f32_32x32x16_bf16 v[48:63], v[144:147], v[152:155], v[48:63]
  ds_read_b64 v[112:113], v76 offset:288
  ds_read_b64 v[114:115], v76 offset:296
  ds_read_b128 v[120:123], v77 offset:2912
  s_mov_b32 s51, 454400
  buffer_load_dwordx4 a[156:159], v78, s[36:39], s51 offen
  s_waitcnt lgkmcnt(3)
  v_mfma_f32_32x32x16_bf16 v[48:63], v[96:99], v[104:107], v[48:63]
  ds_read_b64 v[128:129], v76 offset:320
  ds_read_b64 v[130:131], v76 offset:328
  ds_read_b128 v[136:139], v77 offset:2960
  s_mov_b32 s51, 460800
  buffer_load_dwordx4 a[160:163], v78, s[36:39], s51 offen
  s_waitcnt lgkmcnt(3)
  v_mfma_f32_32x32x16_bf16 v[48:63], v[112:115], v[120:123], v[48:63]
  ds_read_b64 v[144:145], v76 offset:352
  ds_read_b64 v[146:147], v76 offset:360
  ds_read_b128 v[152:155], v77 offset:2992
  s_mov_b32 s51, 467200
  buffer_load_dwordx4 a[164:167], v78, s[36:39], s51 offen
  s_waitcnt lgkmcnt(3)
  v_mfma_f32_32x32x16_bf16 v[48:63], v[128:131], v[136:139], v[48:63]
  ds_read_b64 v[96:97], v76 offset:384
  ds_read_b64 v[98:99], v76 offset:392
  ds_read_b128 v[104:107], v77 offset:3040
  s_mov_b32 s51, 473600
  buffer_load_dwordx4 a[168:171], v78, s[36:39], s51 offen
  s_waitcnt lgkmcnt(3)
  v_mfma_f32_32x32x16_bf16 v[48:63], v[144:147], v[152:155], v[48:63]
  ds_read_b64 v[112:113], v76 offset:416
  ds_read_b64 v[114:115], v76 offset:424
  ds_read_b128 v[120:123], v77 offset:3072
  s_mov_b32 s51, 480000
  buffer_load_dwordx4 a[172:175], v78, s[36:39], s51 offen
  s_waitcnt lgkmcnt(3)
  v_mfma_f32_32x32x16_bf16 v[48:63], v[96:99], v[104:107], v[48:63]
  ds_read_b64 v[128:129], v76 offset:448
  ds_read_b64 v[130:131], v76 offset:456
  ds_read_b128 v[136:139], v77 offset:3120
  s_mov_b32 s51, 486400
  buffer_load_dwordx4 a[176:179], v78, s[36:39], s51 offen
  s_waitcnt lgkmcnt(3)
  v_mfma_f32_32x32x16_bf16 v[48:63], v[112:115], v[120:123], v[48:63]
  ds_read_b64 v[144:145], v76 offset:480
  ds_read_b64 v[146:147], v76 offset:488
  ds_read_b128 v[152:155], v77 offset:3152
  s_mov_b32 s51, 492800
  buffer_load_dwordx4 a[180:183], v78, s[36:39], s51 offen
  s_waitcnt lgkmcnt(3)
  v_mfma_f32_32x32x16_bf16 v[48:63], v[128:131], v[136:139], v[48:63]
  s_mov_b32 s51, 499200
  buffer_load_dwordx4 a[184:187], v78, s[36:39], s51 offen
  s_waitcnt lgkmcnt(0)
  v_mfma_f32_32x32x16_bf16 v[48:63], v[144:147], v[152:155], v[48:63]
  s_mov_b32 s51, 505600
  buffer_load_dwordx4 a[188:191], v78, s[36:39], s51 offen
  s_branch L_c2d_300017
L_c2hi_300016:
  ds_read_b64 v[96:97], v76 offset:0
  ds_read_b64 v[98:99], v76 offset:8
  ds_read_b128 v[104:107], v77 offset:2560
  ds_read_b128 v[108:111], v77 offset:0
  ds_read_b64 v[100:101], v76 offset:2048
  ds_read_b64 v[102:103], v76 offset:2056
  ds_read_b64 v[112:113], v76 offset:32
  ds_read_b64 v[114:115], v76 offset:40
  ds_read_b128 v[120:123], v77 offset:2592
  ds_read_b128 v[124:127], v77 offset:32
  ds_read_b64 v[116:117], v76 offset:2080
  ds_read_b64 v[118:119], v76 offset:2088
  s_waitcnt lgkmcnt(6)
  v_mfma_f32_32x32x16_bf16 v[48:63], v[96:99], v[108:111], v[48:63]
  ds_read_b64 v[128:129], v76 offset:64
  ds_read_b64 v[130:131], v76 offset:72
  ds_read_b128 v[136:139], v77 offset:2640
  v_mfma_f32_32x32x16_bf16 v[48:63], v[100:103], v[104:107], v[48:63]
  ds_read_b128 v[140:143], v77 offset:80
  ds_read_b64 v[132:133], v76 offset:2112
  ds_read_b64 v[134:135], v76 offset:2120
  s_mov_b32 s51, 409600
  buffer_load_dwordx4 a[128:131], v78, s[36:39], s51 offen
  s_waitcnt lgkmcnt(6)
  v_mfma_f32_32x32x16_bf16 v[48:63], v[112:115], v[124:127], v[48:63]
  ds_read_b64 v[144:145], v76 offset:96
  ds_read_b64 v[146:147], v76 offset:104
  ds_read_b128 v[152:155], v77 offset:2672
  v_mfma_f32_32x32x16_bf16 v[48:63], v[116:119], v[120:123], v[48:63]
  ds_read_b128 v[156:159], v77 offset:112
  ds_read_b64 v[148:149], v76 offset:2144
  ds_read_b64 v[150:151], v76 offset:2152
  s_mov_b32 s51, 416000
  buffer_load_dwordx4 a[132:135], v78, s[36:39], s51 offen
  s_waitcnt lgkmcnt(6)
  v_mfma_f32_32x32x16_bf16 v[48:63], v[128:131], v[140:143], v[48:63]
  ds_read_b64 v[96:97], v76 offset:128
  ds_read_b64 v[98:99], v76 offset:136
  ds_read_b128 v[104:107], v77 offset:2720
  v_mfma_f32_32x32x16_bf16 v[48:63], v[132:135], v[136:139], v[48:63]
  ds_read_b128 v[108:111], v77 offset:160
  ds_read_b64 v[100:101], v76 offset:2176
  ds_read_b64 v[102:103], v76 offset:2184
  s_mov_b32 s51, 422400
  buffer_load_dwordx4 a[136:139], v78, s[36:39], s51 offen
  s_waitcnt lgkmcnt(6)
  v_mfma_f32_32x32x16_bf16 v[48:63], v[144:147], v[156:159], v[48:63]
  ds_read_b64 v[112:113], v76 offset:160
  ds_read_b64 v[114:115], v76 offset:168
  ds_read_b128 v[120:123], v77 offset:2752
  v_mfma_f32_32x32x16_bf16 v[48:63], v[148:151], v[152:155], v[48:63]
  ds_read_b128 v[124:127], v77 offset:192
  ds_read_b64 v[116:117], v76 offset:2208
  ds_read_b64 v[118:119], v76 offset:2216
  s_mov_b32 s51, 428800
  buffer_load_dwordx4 a[140:143], v78, s[36:39], s51 offen
  s_waitcnt lgkmcnt(6)
  v_mfma_f32_32x32x16_bf16 v[48:63], v[96:99], v[108:111], v[48:63]
  ds_read_b64 v[128:129], v76 offset:192
  ds_read_b64 v[130:131], v76 offset:200
  ds_read_b128 v[136:139], v77 offset:2800
  v_mfma_f32_32x32x16_bf16 v[48:63], v[100:103], v[104:107], v[48:63]
  ds_read_b128 v[140:143], v77 offset:240
  ds_read_b64 v[132:133], v76 offset:2240
  ds_read_b64 v[134:135], v76 offset:2248
  s_mov_b32 s51, 435200
  buffer_load_dwordx4 a[144:147], v78, s[36:39], s51 offen
  s_waitcnt lgkmcnt(6)
  v_mfma_f32_32x32x16_bf16 v[48:63], v[112:115], v[124:127], v[48:63]
  ds_read_b64 v[144:145], v76 offset:224
  ds_read_b64 v[146:147], v76 offset:232
  ds_read_b128 v[152:155], v77 offset:2832
  v_mfma_f32_32x32x16_bf16 v[48:63], v[116:119], v[120:123], v[48:63]
  ds_read_b128 v[156:159], v77 offset:272
  ds_read_b64 v[148:149], v76 offset:2272
  ds_read_b64 v[150:151], v76 offset:2280
  s_mov_b32 s51, 441600
  buffer_load_dwordx4 a[148:151], v78, s[36:39], s51 offen
  s_waitcnt lgkmcnt(6)
  v_mfma_f32_32x32x16_bf16 v[48:63], v[128:131], v[140:143], v[48:63]
  ds_read_b64 v[96:97], v76 offset:256
  ds_read_b64 v[98:99], v76 offset:264
  ds_read_b128 v[104:107], v77 offset:2880
  v_mfma_f32_32x32x16_bf16 v[48:63], v[132:135], v[136:139], v[48:63]
  ds_read_b128 v[108:111], v77 offset:320
  ds_read_b64 v[100:101], v76 offset:2304
  ds_read_b64 v[102:103], v76 offset:2312
  s_mov_b32 s51, 448000
  buffer_load_dwordx4 a[152:155], v78, s[36:39], s51 offen
  s_waitcnt lgkmcnt(6)
  v_mfma_f32_32x32x16_bf16 v[48:63], v[144:147], v[156:159], v[48:63]
  ds_read_b64 v[112:113], v76 offset:288
  ds_read_b64 v[114:115], v76 offset:296
  ds_read_b128 v[120:123], v77 offset:2912
  v_mfma_f32_32x32x16_bf16 v[48:63], v[148:151], v[152:155], v[48:63]
  ds_read_b128 v[124:127], v77 offset:352
  ds_read_b64 v[116:117], v76 offset:2336
  ds_read_b64 v[118:119], v76 offset:2344
  s_mov_b32 s51, 454400
  buffer_load_dwordx4 a[156:159], v78, s[36:39], s51 offen
  s_waitcnt lgkmcnt(6)
  v_mfma_f32_32x32x16_bf16 v[48:63], v[96:99], v[108:111], v[48:63]
  ds_read_b64 v[128:129], v76 offset:320
  ds_read_b64 v[130:131], v76 offset:328
  ds_read_b128 v[136:139], v77 offset:2960
  v_mfma_f32_32x32x16_bf16 v[48:63], v[100:103], v[104:107], v[48:63]
  ds_read_b128 v[140:143], v77 offset:400
  ds_read_b64 v[132:133], v76 offset:2368
  ds_read_b64 v[134:135], v76 offset:2376
  s_mov_b32 s51, 460800
  buffer_load_dwordx4 a[160:163], v78, s[36:39], s51 offen
  s_waitcnt lgkmcnt(6)
  v_mfma_f32_32x32x16_bf16 v[48:63], v[112:115], v[124:127], v[48:63]
  ds_read_b64 v[144:145], v76 offset:352
  ds_read_b64 v[146:147], v76 offset:360
  ds_read_b128 v[152:155], v77 offset:2992
  v_mfma_f32_32x32x16_bf16 v[48:63], v[116:119], v[120:123], v[48:63]
  ds_read_b128 v[156:159], v77 offset:432
  ds_read_b64 v[148:149], v76 offset:2400
  ds_read_b64 v[150:151], v76 offset:2408
  s_mov_b32 s51, 467200
  buffer_load_dwordx4 a[164:167], v78, s[36:39], s51 offen
  s_waitcnt lgkmcnt(6)
  v_mfma_f32_32x32x16_bf16 v[48:63], v[128:131], v[140:143], v[48:63]
  ds_read_b64 v[96:97], v76 offset:384
  ds_read_b64 v[98:99], v76 offset:392
  ds_read_b128 v[104:107], v77 offset:3040
  v_mfma_f32_32x32x16_bf16 v[48:63], v[132:135], v[136:139], v[48:63]
  ds_read_b128 v[108:111], v77 offset:480
  ds_read_b64 v[100:101], v76 offset:2432
  ds_read_b64 v[102:103], v76 offset:2440
  s_mov_b32 s51, 473600
  buffer_load_dwordx4 a[168:171], v78, s[36:39], s51 offen
  s_waitcnt lgkmcnt(6)
  v_mfma_f32_32x32x16_bf16 v[48:63], v[144:147], v[156:159], v[48:63]
  ds_read_b64 v[112:113], v76 offset:416
  ds_read_b64 v[114:115], v76 offset:424
  ds_read_b128 v[120:123], v77 offset:3072
  v_mfma_f32_32x32x16_bf16 v[48:63], v[148:151], v[152:155], v[48:63]
  ds_read_b128 v[124:127], v77 offset:512
  ds_read_b64 v[116:117], v76 offset:2464
  ds_read_b64 v[118:119], v76 offset:2472
  s_mov_b32 s51, 480000
  buffer_load_dwordx4 a[172:175], v78, s[36:39], s51 offen
  s_waitcnt lgkmcnt(6)
  v_mfma_f32_32x32x16_bf16 v[48:63], v[96:99], v[108:111], v[48:63]
  ds_read_b64 v[128:129], v76 offset:448
  ds_read_b64 v[130:131], v76 offset:456
  ds_read_b128 v[136:139], v77 offset:3120
  v_mfma_f32_32x32x16_bf16 v[48:63], v[100:103], v[104:107], v[48:63]
  ds_read_b128 v[140:143], v77 offset:560
  ds_read_b64 v[132:133], v76 offset:2496
  ds_read_b64 v[134:135], v76 offset:2504
  s_mov_b32 s51, 486400
  buffer_load_dwordx4 a[176:179], v78, s[36:39], s51 offen
  s_waitcnt lgkmcnt(6)
  v_mfma_f32_32x32x16_bf16 v[48:63], v[112:115], v[124:127], v[48:63]
  ds_read_b64 v[144:145], v76 offset:480
  ds_read_b64 v[146:147], v76 offset:488
  ds_read_b128 v[152:155], v77 offset:3152
  v_mfma_f32_32x32x16_bf16 v[48:63], v[116:119], v[120:123], v[48:63]
  ds_read_b128 v[156:159], v77 offset:592
  ds_read_b64 v[148:149], v76 offset:2528
  ds_read_b64 v[150:151], v76 offset:2536
  s_mov_b32 s51, 492800
  buffer_load_dwordx4 a[180:183], v78, s[36:39], s51 offen
  s_waitcnt lgkmcnt(6)
  v_mfma_f32_32x32x16_bf16 v[48:63], v[128:131], v[140:143], v[48:63]
  v_mfma_f32_32x32x16_bf16 v[48:63], v[132:135], v[136:139], v[48:63]
  s_mov_b32 s51, 499200
  buffer_load_dwordx4 a[184:187], v78, s[36:39], s51 offen
  s_waitcnt lgkmcnt(0)
  v_mfma_f32_32x32x16_bf16 v[48:63], v[144:147], v[156:159], v[48:63]
  v_mfma_f32_32x32x16_bf16 v[48:63], v[148:151], v[152:155], v[48:63]
  s_mov_b32 s51, 505600
  buffer_load_dwordx4 a[188:191], v78, s[36:39], s51 offen
L_c2d_300017:
  global_load_dword v79, v15, s[56:57] sc1
  s_waitcnt vmcnt(33)
  s_mov_b32 exec_lo, 0x33333333
  s_mov_b32 exec_hi, 0x3333333
  ds_write_b128 v91, a[0:3] offset:5120
  ds_write_b128 v91, a[4:7] offset:5440
  ds_write_b128 v91, a[8:11] offset:5760
  ds_write_b128 v91, a[12:15] offset:6080
  ds_write_b128 v91, a[16:19] offset:6400
  ds_write_b128 v91, a[20:23] offset:6720
  ds_write_b128 v91, a[24:27] offset:7040
  ds_write_b128 v91, a[28:31] offset:7360
  ds_write_b128 v91, a[32:35] offset:7680
  ds_write_b128 v91, a[36:39] offset:8000
  ds_write_b128 v91, a[40:43] offset:8320
  ds_write_b128 v91, a[44:47] offset:8640
  ds_write_b128 v91, a[48:51] offset:8960
  ds_write_b128 v91, a[52:55] offset:9280
  ds_write_b128 v91, a[56:59] offset:9600
  ds_write_b128 v91, a[60:63] offset:9920
  s_mov_b32 exec_lo, 0x44444444
  s_mov_b32 exec_hi, 0x4444444
  ds_write_b64 v91, a[0:1] offset:5120
  ds_write_b64 v91, a[4:5] offset:5440
  ds_write_b64 v91, a[8:9] offset:5760
  ds_write_b64 v91, a[12:13] offset:6080
  ds_write_b64 v91, a[16:17] offset:6400
  ds_write_b64 v91, a[20:21] offset:6720
  ds_write_b64 v91, a[24:25] offset:7040
  ds_write_b64 v91, a[28:29] offset:7360
  ds_write_b64 v91, a[32:33] offset:7680
  ds_write_b64 v91, a[36:37] offset:8000
  ds_write_b64 v91, a[40:41] offset:8320
  ds_write_b64 v91, a[44:45] offset:8640
  ds_write_b64 v91, a[48:49] offset:8960
  ds_write_b64 v91, a[52:53] offset:9280
  ds_write_b64 v91, a[56:57] offset:9600
  ds_write_b64 v91, a[60:61] offset:9920
  s_mov_b64 exec, -1
  s_barrier
  s_cmp_lg_u32 s90, 0
  s_cbranch_scc1 L_cx_300018
  ds_write_b128 v66, v[32:35] offset:0
  ds_write_b128 v66, v[36:39] offset:1024
  ds_write_b128 v66, v[40:43] offset:2048
  ds_write_b128 v66, v[44:47] offset:3072
  s_branch L_cy_300019
L_cx_300018:
  ds_write_b128 v66, v[16:19] offset:0
  ds_write_b128 v66, v[20:23] offset:1024
  ds_write_b128 v66, v[24:27] offset:2048
  ds_write_b128 v66, v[28:31] offset:3072
L_cy_300019:
  ds_write_b128 v65, v[48:51] offset:0
  ds_write_b128 v65, v[52:55] offset:1024
  ds_write_b128 v65, v[56:59] offset:2048
  ds_write_b128 v65, v[60:63] offset:3072
  s_waitcnt lgkmcnt(0)
  s_barrier
  ds_read_b128 v[96:99], v67 offset:0
  ds_read_b128 v[100:103], v67 offset:1024
  ds_read_b128 v[104:107], v67 offset:2048
  ds_read_b128 v[108:111], v67 offset:3072
  ds_read_b128 v[112:115], v64 offset:0
  ds_read_b128 v[116:119], v64 offset:4096
  ds_read_b128 v[120:123], v64 offset:8192
  ds_read_b128 v[124:127], v64 offset:12288
  s_cmp_lg_u32 s90, 0
  s_cbranch_scc1 L_cx_300020
  s_waitcnt lgkmcnt(7)
  v_pk_add_f32 v[16:17], v[16:17], v[96:97]
  v_pk_add_f32 v[18:19], v[18:19], v[98:99]
  v_cvt_pk_bf16_f32 v128, v16, v17
  v_cvt_pk_bf16_f32 v129, v18, v19
  s_waitcnt lgkmcnt(6)
  v_pk_add_f32 v[20:21], v[20:21], v[100:101]
  v_pk_add_f32 v[22:23], v[22:23], v[102:103]
  v_cvt_pk_bf16_f32 v130, v20, v21
  v_cvt_pk_bf16_f32 v131, v22, v23
  s_waitcnt lgkmcnt(5)
  v_pk_add_f32 v[24:25], v[24:25], v[104:105]
  v_pk_add_f32 v[26:27], v[26:27], v[106:107]
  v_cvt_pk_bf16_f32 v132, v24, v25
  v_cvt_pk_bf16_f32 v133, v26, v27
  s_waitcnt lgkmcnt(4)
  v_pk_add_f32 v[28:29], v[28:29], v[108:109]
  v_pk_add_f32 v[30:31], v[30:31], v[110:111]
  v_cvt_pk_bf16_f32 v134, v28, v29
  v_cvt_pk_bf16_f32 v135, v30, v31
  s_branch L_cy_300021
L_cx_300020:
  s_waitcnt lgkmcnt(7)
  v_pk_add_f32 v[32:33], v[32:33], v[96:97]
  v_pk_add_f32 v[34:35], v[34:35], v[98:99]
  v_cvt_pk_bf16_f32 v128, v32, v33
  v_cvt_pk_bf16_f32 v129, v34, v35
  s_waitcnt lgkmcnt(6)
  v_pk_add_f32 v[36:37], v[36:37], v[100:101]
  v_pk_add_f32 v[38:39], v[38:39], v[102:103]
  v_cvt_pk_bf16_f32 v130, v36, v37
  v_cvt_pk_bf16_f32 v131, v38, v39
  s_waitcnt lgkmcnt(5)
  v_pk_add_f32 v[40:41], v[40:41], v[104:105]
  v_pk_add_f32 v[42:43], v[42:43], v[106:107]
  v_cvt_pk_bf16_f32 v132, v40, v41
  v_cvt_pk_bf16_f32 v133, v42, v43
  s_waitcnt lgkmcnt(4)
  v_pk_add_f32 v[44:45], v[44:45], v[108:109]
  v_pk_add_f32 v[46:47], v[46:47], v[110:111]
  v_cvt_pk_bf16_f32 v134, v44, v45
  v_cvt_pk_bf16_f32 v135, v46, v47
L_cy_300021:
  ds_write_b64 v71, v[128:129] offset:0
  ds_write_b64 v71, v[130:131] offset:16
  ds_write_b64 v71, v[132:133] offset:32
  ds_write_b64 v71, v[134:135] offset:48
  s_waitcnt lgkmcnt(4)
  v_pk_add_f32 v[112:113], v[112:113], v[116:117]
  v_pk_add_f32 v[120:121], v[120:121], v[124:125]
  v_pk_add_f32 v[114:115], v[114:115], v[118:119]
  v_pk_add_f32 v[122:123], v[122:123], v[126:127]
  v_pk_add_f32 v[112:113], v[112:113], v[120:121]
  v_pk_add_f32 v[114:115], v[114:115], v[122:123]
  v_cvt_pk_bf16_f32 v136, v112, v113
  v_cvt_pk_bf16_f32 v137, v114, v115
  ds_write_b64 v70, v[136:137]
  ds_read_b128 v[16:19], v72
  ds_read_b128 v[20:23], v72 offset:1024
  s_and_b32 s50, s29, 1
  s_lshl_b32 s50, s50, 11
  s_lshl_b32 s51, s91, 12
  s_add_u32 s50, s50, s51
  s_add_u32 s50, s50, 0x2100000
  s_waitcnt lgkmcnt(0)
  global_store_dwordx4 v73, v[16:19], s[26:27] sc1
  global_store_dwordx4 v73, v[20:23], s[26:27] offset:1024 sc1
  s_barrier
  v_and_b32 v67, 127, v0
  v_lshlrev_b32 v67, 4, v67
  v_add_u32 v66, 143360, v67
  v_add_u32 v65, s50, v67
  ds_read_b128 v[24:27], v66
  s_waitcnt lgkmcnt(0)
  global_store_dwordx4 v65, v[24:27], s[26:27] sc1
  s_waitcnt vmcnt(3)
  v_cmp_ne_u32 vcc, s34, v79
  s_nop 0
  s_and_b64 vcc, vcc, s[4:5]
  s_cbranch_scc0 L_zok_300022
L_poll_300023:
  global_load_dword v4, v15, s[56:57] sc1
  s_cmp_eq_u32 s64, 0
  s_cbranch_scc1 L_polld_300024
  s_sub_u32 s64, s64, 1
  s_waitcnt vmcnt(0)
  v_cmp_ne_u32 vcc, s34, v4
  s_nop 0
  s_and_b64 vcc, vcc, s[4:5]
  s_cbranch_scc1 L_poll_300023
L_polld_300024:
L_zok_300022:
  global_load_dwordx4 v[96:99], v8, s[66:67] offset:0 sc1
  global_load_dwordx4 v[100:103], v9, s[66:67] offset:0 sc1
  global_load_dwordx4 v[104:107], v8, s[66:67] offset:1024 sc1
  global_load_dwordx4 v[108:111], v9, s[66:67] offset:1024 sc1
  global_load_dwordx4 v[112:115], v8, s[66:67] offset:2048 sc1
  global_load_dwordx4 v[116:119], v9, s[66:67] offset:2048 sc1
  global_load_dwordx4 v[120:123], v8, s[66:67] offset:3072 sc1
  global_load_dwordx4 v[124:127], v9, s[66:67] offset:3072 sc1
  v_add_u32 v8, 4096, v8
  v_add_u32 v9, 4096, v9
  global_load_dwordx4 v[128:131], v8, s[66:67] offset:0 sc1
  global_load_dwordx4 v[132:135], v9, s[66:67] offset:0 sc1
  global_load_dwordx4 v[136:139], v8, s[66:67] offset:1024 sc1
  global_load_dwordx4 v[140:143], v9, s[66:67] offset:1024 sc1
  global_load_dwordx4 v[144:147], v8, s[66:67] offset:2048 sc1
  global_load_dwordx4 v[148:151], v9, s[66:67] offset:2048 sc1
  global_load_dwordx4 v[152:155], v8, s[66:67] offset:3072 sc1
  global_load_dwordx4 v[156:159], v9, s[66:67] offset:3072 sc1
  v_add_u32 v8, 4096, v8
  v_add_u32 v9, 4096, v9
  v_xor_b32 v4, 48, v224
  ds_write_b64 v4, v[88:89]
  s_waitcnt lgkmcnt(0)
  s_barrier
  v_mfma_f32_32x32x16_bf16 v[16:31], v[92:95], v[92:95], 0
  v_mfma_f32_32x32x16_bf16 v[32:47], v[92:95], v[92:95], 0
  v_mfma_f32_32x32x16_bf16 v[48:63], v[92:95], v[92:95], 0
  v_mfma_f32_32x32x16_bf16 v[64:79], v[92:95], v[92:95], 0
  v_mfma_f32_32x32x16_bf16 v[176:191], v[92:95], v[92:95], 0
  v_mfma_f32_32x32x16_bf16 v[192:207], v[92:95], v[92:95], 0
  ds_read_b64_tr_b16 v[160:161], v10 offset:0
  ds_read_b64_tr_b16 v[162:163], v10 offset:256
  ds_read_b64_tr_b16 v[164:165], v11 offset:0
  ds_read_b64_tr_b16 v[166:167], v11 offset:256
  s_branch L_QKV
L_LAYER:
  s_lshl_b32 s48, s33, 3
  s_add_u32 s48, s48, s28
  s_mul_i32 s45, s28, 327680
  s_add_u32 s66, s26, 0x100000
  s_addc_u32 s67, s27, 0
  s_add_u32 s66, s66, s45
  s_addc_u32 s67, s67, 0
  s_add_u32 s68, s26, 0x1400000
  s_addc_u32 s69, s27, 0
  s_add_u32 s68, s68, s45
  s_addc_u32 s69, s69, 0
  s_add_u32 s70, s26, 0x1900000
  s_addc_u32 s71, s27, 0
  s_add_u32 s70, s70, s45
  s_addc_u32 s71, s71, 0
  s_mov_b64 s[76:77], s[66:67]
  s_lshl_b32 s46, s48, 5
  s_add_u32 s46, s46, s29
  s_lshl_b32 s78, s46, 7
  s_add_u32 s78, s78, 0x14000
  s_sub_u32 s79, s78, 4096
  s_mul_i32 s46, s46, 28672
  s_add_u32 s72, s26, 0x5ec000
  s_addc_u32 s73, s27, 0
  s_add_u32 s72, s72, s46
  s_addc_u32 s73, s73, 0
  s_sub_u32 s46, s46, 917504
  s_cmp_eq_u32 s28, 0
  s_cselect_b32 s46, 0, s46
  s_add_u32 s74, s26, 0x600000
  s_addc_u32 s75, s27, 0
  s_add_u32 s74, s74, s46
  s_addc_u32 s75, s75, 0
  s_mul_i32 s44, s33, 3
  s_add_u32 s44, s44, 0
  s_lshl_b32 s44, s44, 3
  s_add_u32 s44, s44, s28
  s_lshl_b32 s44, s44, 12
  s_add_u32 s56, s26, 0x40000
  s_addc_u32 s57, s27, 0
  s_add_u32 s56, s56, s44
  s_addc_u32 s57, s57, 0
  s_add_u32 s58, s56, 32768
  s_addc_u32 s59, s57, 0
  s_add_u32 s60, s58, 32768
  s_addc_u32 s61, s59, 0
  s_add_u32 s62, s60, 32768
  s_addc_u32 s63, s61, 0
  s_mul_i32 s34, s33, 3
  s_add_u32 s34, s34, s31
  s_add_u32 s34, s34, 1
  s_add_u32 s35, s31, s33
  s_add_u32 s35, s35, 16
  s_lshl_b32 s44, s30, 11
  s_add_u32 s44, s44, 110592
  v_and_b32 v4, 31, v1
  v_bfe_u32 v5, v4, 1, 3
  v_lshlrev_b32 v4, 6, v4
  v_add_u32 v4, s44, v4
  v_lshrrev_b32 v224, 5, v1
  v_xor_b32 v224, v224, v5
  v_lshl_add_u32 v224, v224, 3, v4
  v_xor_b32 v225, 16, v224
  v_xor_b32 v226, 40, v224
  v_xor_b32 v4, 48, v224
  v_mov_b32 v88, 0x3f80
  v_mov_b32 v89, 0
  ds_write_b64 v4, v[88:89]
  v_bfe_u32 v4, v1, 2, 2
  v_lshrrev_b32 v5, 5, v1
  v_lshl_add_u32 v4, v5, 2, v4
  v_bfe_u32 v5, v1, 4, 1
  v_lshlrev_b32 v5, 2, v5
  v_and_b32 v227, 3, v1
  v_add_u32 v5, v5, v227
  v_lshrrev_b32 v227, 1, v4
  v_xor_b32 v5, v5, v227
  v_lshlrev_b32 v5, 3, v5
  v_lshl_add_u32 v227, v4, 6, v5
  v_add_u32 v227, s44, v227
  v_xor_b32 v228, 32, v227
  s_mov_b32 s45, s30
  s_mul_i32 s46, s45, 1536
  s_add_u32 s46, s46, 81920
  v_add_u32 v229, s46, v2
  s_add_u32 s46, s46, 1024
  v_add_u32 v230, s46, v3
  s_lshl_b32 s46, s45, 11
  s_add_u32 s46, s46, 94208
  v_add_u32 v231, s46, v2
  s_sub_u32 s45, 7, s30
  s_mul_i32 s46, s45, 1536
  s_add_u32 s46, s46, 81920
  v_add_u32 v12, s46, v2
  s_add_u32 s46, s46, 1024
  v_add_u32 v13, s46, v3
  s_lshl_b32 s46, s45, 11
  s_add_u32 s46, s46, 94208
  v_add_u32 v14, s46, v2
  s_mov_b32 s94, 0x3ea52b5c
  s_mov_b32 s95, s94
  v_and_b32 v4, 31, v1
  v_lshrrev_b32 v5, 5, v1
  v_lshlrev_b32 v5, 2, v5
  v_sub_u32 v4, v4, v5
  v_mov_b32 v5, 0xf149f2ca
  v_cmp_le_i32 s[80:81], 0, v4
  v_cmp_le_i32 s[82:83], 1, v4
  s_nop 0
  v_cndmask_b32 v208, v5, 0, s[80:81]
  v_cmp_le_i32 s[84:85], 2, v4
  v_cndmask_b32 v209, v5, 0, s[82:83]
  v_cmp_le_i32 s[86:87], 3, v4
  v_cndmask_b32 v210, v5, 0, s[84:85]
  v_cmp_le_i32 s[80:81], 8, v4
  v_cndmask_b32 v211, v5, 0, s[86:87]
  v_cmp_le_i32 s[82:83], 9, v4
  v_cndmask_b32 v212, v5, 0, s[80:81]
  v_cmp_le_i32 s[84:85], 10, v4
  v_cndmask_b32 v213, v5, 0, s[82:83]
  v_cmp_le_i32 s[86:87], 11, v4
  v_cndmask_b32 v214, v5, 0, s[84:85]
  v_cmp_le_i32 s[80:81], 16, v4
  v_cndmask_b32 v215, v5, 0, s[86:87]
  v_cmp_le_i32 s[82:83], 17, v4
  v_cndmask_b32 v216, v5, 0, s[80:81]
  v_cmp_le_i32 s[84:85], 18, v4
  v_cndmask_b32 v217, v5, 0, s[82:83]
  v_cmp_le_i32 s[86:87], 19, v4
  v_cndmask_b32 v218, v5, 0, s[84:85]
  v_cmp_le_i32 s[80:81], 24, v4
  v_cndmask_b32 v219, v5, 0, s[86:87]
  v_cmp_le_i32 s[82:83], 25, v4
  v_cndmask_b32 v220, v5, 0, s[80:81]
  v_cmp_le_i32 s[84:85], 26, v4
  v_cndmask_b32 v221, v5, 0, s[82:83]
  v_cmp_le_i32 s[86:87], 27, v4
  v_cndmask_b32 v222, v5, 0, s[84:85]
  s_nop 0
  v_cndmask_b32 v223, v5, 0, s[86:87]
  s_mul_i32 s44, s30, 40960
  v_add_u32 v8, s44, v2
  s_sub_u32 s45, 7, s30
  s_mul_i32 s45, s45, 40960
  v_add_u32 v9, s45, v2
  v_lshrrev_b32 v4, 5, v1
  v_lshlrev_b32 v4, 3, v4
  v_bfe_u32 v5, v1, 2, 2
  v_add_u32 v4, v4, v5
  v_lshlrev_b32 v4, 6, v4
  v_bfe_u32 v5, v1, 4, 1
  v_lshlrev_b32 v5, 5, v5
  v_and_b32 v10, 3, v1
  v_lshlrev_b32 v10, 3, v10
  v_add3_u32 v10, v4, v5, v10
  v_add_u32 v11, 40960, v10
  v_mfma_f32_32x32x16_bf16 v[16:31], v[92:95], v[92:95], 0
  v_mfma_f32_32x32x16_bf16 v[32:47], v[92:95], v[92:95], 0
  v_mfma_f32_32x32x16_bf16 v[48:63], v[92:95], v[92:95], 0
  v_mfma_f32_32x32x16_bf16 v[64:79], v[92:95], v[92:95], 0
  v_mfma_f32_32x32x16_bf16 v[176:191], v[92:95], v[92:95], 0
  v_mfma_f32_32x32x16_bf16 v[192:207], v[92:95], v[92:95], 0
  ds_read_b64_tr_b16 v[160:161], v10 offset:0
  ds_read_b64_tr_b16 v[162:163], v10 offset:256
  ds_read_b64_tr_b16 v[164:165], v11 offset:0
  ds_read_b64_tr_b16 v[166:167], v11 offset:256
L_poll_300025:
  global_load_dword v4, v15, s[56:57] sc1
  s_cmp_eq_u32 s64, 0
  s_cbranch_scc1 L_polld_300026
  s_sub_u32 s64, s64, 1
  s_waitcnt vmcnt(0)
  v_cmp_ne_u32 vcc, s34, v4
  s_nop 0
  s_and_b64 vcc, vcc, s[4:5]
  s_cbranch_scc1 L_poll_300025
L_polld_300026:
  global_load_dwordx4 v[96:99], v8, s[66:67] offset:0 sc1
  global_load_dwordx4 v[100:103], v9, s[66:67] offset:0 sc1
  global_load_dwordx4 v[104:107], v8, s[66:67] offset:1024 sc1
  global_load_dwordx4 v[108:111], v9, s[66:67] offset:1024 sc1
  global_load_dwordx4 v[112:115], v8, s[66:67] offset:2048 sc1
  global_load_dwordx4 v[116:119], v9, s[66:67] offset:2048 sc1
  global_load_dwordx4 v[120:123], v8, s[66:67] offset:3072 sc1
  global_load_dwordx4 v[124:127], v9, s[66:67] offset:3072 sc1
  v_add_u32 v8, 4096, v8
  v_add_u32 v9, 4096, v9
  global_load_dwordx4 v[128:131], v8, s[66:67] offset:0 sc1
  global_load_dwordx4 v[132:135], v9, s[66:67] offset:0 sc1
  global_load_dwordx4 v[136:139], v8, s[66:67] offset:1024 sc1
  global_load_dwordx4 v[140:143], v9, s[66:67] offset:1024 sc1
  global_load_dwordx4 v[144:147], v8, s[66:67] offset:2048 sc1
  global_load_dwordx4 v[148:151], v9, s[66:67] offset:2048 sc1
  global_load_dwordx4 v[152:155], v8, s[66:67] offset:3072 sc1
  global_load_dwordx4 v[156:159], v9, s[66:67] offset:3072 sc1
  v_add_u32 v8, 4096, v8
  v_add_u32 v9, 4096, v9
L_QKV:
  s_mov_b32 s80, -4
L_qkv_300027:
  s_waitcnt vmcnt(15) lgkmcnt(0)
  v_mfma_f32_32x32x16_bf16 v[16:31], v[160:163], v[96:99], v[16:31]
  ds_read_b64_tr_b16 v[168:169], v10 offset:1024
  ds_read_b64_tr_b16 v[170:171], v10 offset:1280
  v_mfma_f32_32x32x16_bf16 v[32:47], v[164:167], v[96:99], v[32:47]
  ds_read_b64_tr_b16 v[172:173], v11 offset:1024
  ds_read_b64_tr_b16 v[174:175], v11 offset:1280
  global_load_dwordx4 v[96:99], v8, s[66:67] offset:0 sc1
  s_waitcnt vmcnt(15)
  v_mfma_f32_32x32x16_bf16 v[48:63], v[160:163], v[100:103], v[48:63]
  v_mfma_f32_32x32x16_bf16 v[64:79], v[164:167], v[100:103], v[64:79]
  global_load_dwordx4 v[100:103], v9, s[66:67] offset:0 sc1
  s_waitcnt vmcnt(15) lgkmcnt(0)
  v_mfma_f32_32x32x16_bf16 v[16:31], v[168:171], v[104:107], v[16:31]
  ds_read_b64_tr_b16 v[160:161], v10 offset:2048
  ds_read_b64_tr_b16 v[162:163], v10 offset:2304
  v_mfma_f32_32x32x16_bf16 v[32:47], v[172:175], v[104:107], v[32:47]
  ds_read_b64_tr_b16 v[164:165], v11 offset:2048
  ds_read_b64_tr_b16 v[166:167], v11 offset:2304
  global_load_dwordx4 v[104:107], v8, s[66:67] offset:1024 sc1
  s_waitcnt vmcnt(15)
  v_mfma_f32_32x32x16_bf16 v[48:63], v[168:171], v[108:111], v[48:63]
  v_mfma_f32_32x32x16_bf16 v[64:79], v[172:175], v[108:111], v[64:79]
  global_load_dwordx4 v[108:111], v9, s[66:67] offset:1024 sc1
  s_waitcnt vmcnt(15) lgkmcnt(0)
  v_mfma_f32_32x32x16_bf16 v[16:31], v[160:163], v[112:115], v[16:31]
  ds_read_b64_tr_b16 v[168:169], v10 offset:3072
  ds_read_b64_tr_b16 v[170:171], v10 offset:3328
  v_mfma_f32_32x32x16_bf16 v[32:47], v[164:167], v[112:115], v[32:47]
  ds_read_b64_tr_b16 v[172:173], v11 offset:3072
  ds_read_b64_tr_b16 v[174:175], v11 offset:3328
  global_load_dwordx4 v[112:115], v8, s[66:67] offset:2048 sc1
  s_waitcnt vmcnt(15)
  v_mfma_f32_32x32x16_bf16 v[48:63], v[160:163], v[116:119], v[48:63]
  v_mfma_f32_32x32x16_bf16 v[64:79], v[164:167], v[116:119], v[64:79]
  global_load_dwordx4 v[116:119], v9, s[66:67] offset:2048 sc1
  s_waitcnt vmcnt(15) lgkmcnt(0)
  v_mfma_f32_32x32x16_bf16 v[16:31], v[168:171], v[120:123], v[16:31]
  ds_read_b64_tr_b16 v[160:161], v10 offset:4096
  ds_read_b64_tr_b16 v[162:163], v10 offset:4352
  v_mfma_f32_32x32x16_bf16 v[32:47], v[172:175], v[120:123], v[32:47]
  ds_read_b64_tr_b16 v[164:165], v11 offset:4096
  ds_read_b64_tr_b16 v[166:167], v11 offset:4352
  global_load_dwordx4 v[120:123], v8, s[66:67] offset:3072 sc1
  s_waitcnt vmcnt(15)
  v_mfma_f32_32x32x16_bf16 v[48:63], v[168:171], v[124:127], v[48:63]
  v_add_u32 v8, 4096, v8
  v_mfma_f32_32x32x16_bf16 v[64:79], v[172:175], v[124:127], v[64:79]
  global_load_dwordx4 v[124:127], v9, s[66:67] offset:3072 sc1
  v_add_u32 v9, 4096, v9
  s_waitcnt vmcnt(15) lgkmcnt(0)
  v_mfma_f32_32x32x16_bf16 v[16:31], v[160:163], v[128:131], v[16:31]
  ds_read_b64_tr_b16 v[168:169], v10 offset:5120
  ds_read_b64_tr_b16 v[170:171], v10 offset:5376
  v_mfma_f32_32x32x16_bf16 v[32:47], v[164:167], v[128:131], v[32:47]
  ds_read_b64_tr_b16 v[172:173], v11 offset:5120
  ds_read_b64_tr_b16 v[174:175], v11 offset:5376
  global_load_dwordx4 v[128:131], v8, s[66:67] offset:0 sc1
  s_waitcnt vmcnt(15)
  v_mfma_f32_32x32x16_bf16 v[48:63], v[160:163], v[132:135], v[48:63]
  v_mfma_f32_32x32x16_bf16 v[64:79], v[164:167], v[132:135], v[64:79]
  global_load_dwordx4 v[132:135], v9, s[66:67] offset:0 sc1
  s_waitcnt vmcnt(15) lgkmcnt(0)
  v_mfma_f32_32x32x16_bf16 v[16:31], v[168:171], v[136:139], v[16:31]
  ds_read_b64_tr_b16 v[160:161], v10 offset:6144
  ds_read_b64_tr_b16 v[162:163], v10 offset:6400
  v_mfma_f32_32x32x16_bf16 v[32:47], v[172:175], v[136:139], v[32:47]
  ds_read_b64_tr_b16 v[164:165], v11 offset:6144
  ds_read_b64_tr_b16 v[166:167], v11 offset:6400
  global_load_dwordx4 v[136:139], v8, s[66:67] offset:1024 sc1
  s_waitcnt vmcnt(15)
  v_mfma_f32_32x32x16_bf16 v[48:63], v[168:171], v[140:143], v[48:63]
  v_mfma_f32_32x32x16_bf16 v[64:79], v[172:175], v[140:143], v[64:79]
  global_load_dwordx4 v[140:143], v9, s[66:67] offset:1024 sc1
  s_waitcnt vmcnt(15) lgkmcnt(0)
  v_mfma_f32_32x32x16_bf16 v[16:31], v[160:163], v[144:147], v[16:31]
  ds_read_b64_tr_b16 v[168:169], v10 offset:7168
  ds_read_b64_tr_b16 v[170:171], v10 offset:7424
  v_mfma_f32_32x32x16_bf16 v[32:47], v[164:167], v[144:147], v[32:47]
  ds_read_b64_tr_b16 v[172:173], v11 offset:7168
  ds_read_b64_tr_b16 v[174:175], v11 offset:7424
  global_load_dwordx4 v[144:147], v8, s[66:67] offset:2048 sc1
  s_waitcnt vmcnt(15)
  v_mfma_f32_32x32x16_bf16 v[48:63], v[160:163], v[148:151], v[48:63]
  v_mfma_f32_32x32x16_bf16 v[64:79], v[164:167], v[148:151], v[64:79]
  global_load_dwordx4 v[148:151], v9, s[66:67] offset:2048 sc1
  s_waitcnt vmcnt(15) lgkmcnt(0)
  v_mfma_f32_32x32x16_bf16 v[16:31], v[168:171], v[152:155], v[16:31]
  ds_read_b64_tr_b16 v[160:161], v10 offset:8192
  ds_read_b64_tr_b16 v[162:163], v10 offset:8448
  v_mfma_f32_32x32x16_bf16 v[32:47], v[172:175], v[152:155], v[32:47]
  ds_read_b64_tr_b16 v[164:165], v11 offset:8192
  ds_read_b64_tr_b16 v[166:167], v11 offset:8448
  global_load_dwordx4 v[152:155], v8, s[66:67] offset:3072 sc1
  s_waitcnt vmcnt(15)
  v_mfma_f32_32x32x16_bf16 v[48:63], v[168:171], v[156:159], v[48:63]
  v_add_u32 v8, 4096, v8
  v_mfma_f32_32x32x16_bf16 v[64:79], v[172:175], v[156:159], v[64:79]
  global_load_dwordx4 v[156:159], v9, s[66:67] offset:3072 sc1
  v_add_u32 v9, 4096, v9
  v_add_u32 v10, 8192, v10
  v_add_u32 v11, 8192, v11
  s_add_u32 s80, s80, 1
  s_cbranch_scc0 L_qkv_300027
  s_waitcnt vmcnt(15) lgkmcnt(0)
  v_mfma_f32_32x32x16_bf16 v[16:31], v[160:163], v[96:99], v[16:31]
  ds_read_b64_tr_b16 v[168:169], v10 offset:1024
  ds_read_b64_tr_b16 v[170:171], v10 offset:1280
  v_mfma_f32_32x32x16_bf16 v[32:47], v[164:167], v[96:99], v[32:47]
  ds_read_b64_tr_b16 v[172:173], v11 offset:1024
  ds_read_b64_tr_b16 v[174:175], v11 offset:1280
  s_waitcnt vmcnt(14)
  v_mfma_f32_32x32x16_bf16 v[48:63], v[160:163], v[100:103], v[48:63]
  v_mfma_f32_32x32x16_bf16 v[64:79], v[164:167], v[100:103], v[64:79]
  s_waitcnt vmcnt(13) lgkmcnt(0)
  v_mfma_f32_32x32x16_bf16 v[16:31], v[168:171], v[104:107], v[16:31]
  ds_read_b64_tr_b16 v[160:161], v10 offset:2048
  ds_read_b64_tr_b16 v[162:163], v10 offset:2304
  v_mfma_f32_32x32x16_bf16 v[32:47], v[172:175], v[104:107], v[32:47]
  ds_read_b64_tr_b16 v[164:165], v11 offset:2048
  ds_read_b64_tr_b16 v[166:167], v11 offset:2304
  s_waitcnt vmcnt(12)
  v_mfma_f32_32x32x16_bf16 v[48:63], v[168:171], v[108:111], v[48:63]
  v_mfma_f32_32x32x16_bf16 v[64:79], v[172:175], v[108:111], v[64:79]
  s_waitcnt vmcnt(11) lgkmcnt(0)
  v_mfma_f32_32x32x16_bf16 v[16:31], v[160:163], v[112:115], v[16:31]
  ds_read_b64_tr_b16 v[168:169], v10 offset:3072
  ds_read_b64_tr_b16 v[170:171], v10 offset:3328
  v_mfma_f32_32x32x16_bf16 v[32:47], v[164:167], v[112:115], v[32:47]
  ds_read_b64_tr_b16 v[172:173], v11 offset:3072
  ds_read_b64_tr_b16 v[174:175], v11 offset:3328
  s_waitcnt vmcnt(10)
  v_mfma_f32_32x32x16_bf16 v[48:63], v[160:163], v[116:119], v[48:63]
  v_mfma_f32_32x32x16_bf16 v[64:79], v[164:167], v[116:119], v[64:79]
  s_waitcnt vmcnt(9) lgkmcnt(0)
  v_mfma_f32_32x32x16_bf16 v[16:31], v[168:171], v[120:123], v[16:31]
  ds_read_b64_tr_b16 v[160:161], v10 offset:4096
  ds_read_b64_tr_b16 v[162:163], v10 offset:4352
  v_mfma_f32_32x32x16_bf16 v[32:47], v[172:175], v[120:123], v[32:47]
  ds_read_b64_tr_b16 v[164:165], v11 offset:4096
  ds_read_b64_tr_b16 v[166:167], v11 offset:4352
  s_waitcnt vmcnt(8)
  v_mfma_f32_32x32x16_bf16 v[48:63], v[168:171], v[124:127], v[48:63]
  v_mfma_f32_32x32x16_bf16 v[64:79], v[172:175], v[124:127], v[64:79]
  s_waitcnt vmcnt(7) lgkmcnt(0)
  v_mfma_f32_32x32x16_bf16 v[16:31], v[160:163], v[128:131], v[16:31]
  ds_read_b64_tr_b16 v[168:169], v10 offset:5120
  ds_read_b64_tr_b16 v[170:171], v10 offset:5376
  v_mfma_f32_32x32x16_bf16 v[32:47], v[164:167], v[128:131], v[32:47]
  ds_read_b64_tr_b16 v[172:173], v11 offset:5120
  ds_read_b64_tr_b16 v[174:175], v11 offset:5376
  s_waitcnt vmcnt(6)
  v_mfma_f32_32x32x16_bf16 v[48:63], v[160:163], v[132:135], v[48:63]
  v_mfma_f32_32x32x16_bf16 v[64:79], v[164:167], v[132:135], v[64:79]
  s_waitcnt vmcnt(5) lgkmcnt(0)
  v_mfma_f32_32x32x16_bf16 v[16:31], v[168:171], v[136:139], v[16:31]
  ds_read_b64_tr_b16 v[160:161], v10 offset:6144
  ds_read_b64_tr_b16 v[162:163], v10 offset:6400
  v_mfma_f32_32x32x16_bf16 v[32:47], v[172:175], v[136:139], v[32:47]
  ds_read_b64_tr_b16 v[164:165], v11 offset:6144
  ds_read_b64_tr_b16 v[166:167], v11 offset:6400
  s_waitcnt vmcnt(4)
  v_mfma_f32_32x32x16_bf16 v[48:63], v[168:171], v[140:143], v[48:63]
  v_mfma_f32_32x32x16_bf16 v[64:79], v[172:175], v[140:143], v[64:79]
  s_waitcnt vmcnt(3) lgkmcnt(0)
  v_mfma_f32_32x32x16_bf16 v[16:31], v[160:163], v[144:147], v[16:31]
  ds_read_b64_tr_b16 v[168:169], v10 offset:7168
  ds_read_b64_tr_b16 v[170:171], v10 offset:7424
  v_mfma_f32_32x32x16_bf16 v[32:47], v[164:167], v[144:147], v[32:47]
  ds_read_b64_tr_b16 v[172:173], v11 offset:7168
  ds_read_b64_tr_b16 v[174:175], v11 offset:7424
  s_waitcnt vmcnt(2)
  v_mfma_f32_32x32x16_bf16 v[48:63], v[160:163], v[148:151], v[48:63]
  v_mfma_f32_32x32x16_bf16 v[64:79], v[164:167], v[148:151], v[64:79]
  s_waitcnt vmcnt(1) lgkmcnt(0)
  v_mfma_f32_32x32x16_bf16 v[16:31], v[168:171], v[152:155], v[16:31]
  v_mfma_f32_32x32x16_bf16 v[32:47], v[172:175], v[152:155], v[32:47]
  s_waitcnt vmcnt(0)
  v_mfma_f32_32x32x16_bf16 v[48:63], v[168:171], v[156:159], v[48:63]
  v_mfma_f32_32x32x16_bf16 v[64:79], v[172:175], v[156:159], v[64:79]
  s_nop 8
  v_cvt_pk_bf16_f32 v100, v36, v37
  v_cvt_pk_bf16_f32 v101, v38, v39
  v_cvt_pk_bf16_f32 v102, v40, v41
  v_cvt_pk_bf16_f32 v103, v42, v43
  v_cvt_pk_bf16_f32 v104, v44, v45
  v_cvt_pk_bf16_f32 v105, v46, v47
  ds_write_b64 v226, v[100:101]
  ds_write_b64 v224, v[102:103]
  ds_write_b64 v225, v[104:105]
  v_cvt_pk_bf16_f32 v96, v24, v25
  v_cvt_pk_bf16_f32 v97, v26, v27
  v_cvt_pk_bf16_f32 v98, v28, v29
  v_cvt_pk_bf16_f32 v99, v30, v31
  ds_read_b64_tr_b16 v[108:109], v227 offset:0
  ds_read_b64_tr_b16 v[110:111], v228 offset:512
  ds_read_b64_tr_b16 v[112:113], v227 offset:1024
  ds_read_b64_tr_b16 v[114:115], v228 offset:1536
  ds_write_b128 v229, v[96:99]
  ds_write_b64 v230, v[100:101]
  global_store_dwordx4 v229, v[96:99], s[72:73] sc1
  global_store_dwordx2 v230, v[100:101], s[72:73] sc1
  v_pk_mul_f32 v[16:17], v[16:17], s[94:95]
  v_pk_mul_f32 v[18:19], v[18:19], s[94:95]
  v_pk_mul_f32 v[20:21], v[20:21], s[94:95]
  v_pk_mul_f32 v[22:23], v[22:23], s[94:95]
  v_pk_mul_f32 v[32:33], v[32:33], s[94:95]
  v_pk_mul_f32 v[34:35], v[34:35], s[94:95]
  v_cvt_pk_bf16_f32 v80, v16, v17
  v_cvt_pk_bf16_f32 v81, v18, v19
  v_cvt_pk_bf16_f32 v82, v20, v21
  v_cvt_pk_bf16_f32 v83, v22, v23
  v_cvt_pk_bf16_f32 v84, v32, v33
  v_cvt_pk_bf16_f32 v85, v34, v35
  s_waitcnt lgkmcnt(2)
  ds_write_b128 v231, v[108:111]
  ds_write_b128 v231, v[112:115] offset:1024
  global_store_dwordx4 v231, v[108:111], s[72:73] sc1
  global_store_dwordx4 v231, v[112:115], s[72:73] offset:1024 sc1
  v_cvt_pk_bf16_f32 v124, v68, v69
  v_cvt_pk_bf16_f32 v125, v70, v71
  v_cvt_pk_bf16_f32 v126, v72, v73
  v_cvt_pk_bf16_f32 v127, v74, v75
  v_cvt_pk_bf16_f32 v128, v76, v77
  v_cvt_pk_bf16_f32 v129, v78, v79
  ds_write_b64 v226, v[124:125]
  ds_write_b64 v224, v[126:127]
  ds_write_b64 v225, v[128:129]
  v_cvt_pk_bf16_f32 v120, v56, v57
  v_cvt_pk_bf16_f32 v121, v58, v59
  v_cvt_pk_bf16_f32 v122, v60, v61
  v_cvt_pk_bf16_f32 v123, v62, v63
  ds_read_b64_tr_b16 v[132:133], v227 offset:0
  ds_read_b64_tr_b16 v[134:135], v228 offset:512
  ds_read_b64_tr_b16 v[136:137], v227 offset:1024
  ds_read_b64_tr_b16 v[138:139], v228 offset:1536
  ds_write_b128 v12, v[120:123]
  ds_write_b64 v13, v[124:125]
  global_store_dwordx4 v12, v[120:123], s[72:73] sc1
  global_store_dwordx2 v13, v[124:125], s[72:73] sc1
  v_pk_mul_f32 v[48:49], v[48:49], s[94:95]
  v_pk_mul_f32 v[50:51], v[50:51], s[94:95]
  v_pk_mul_f32 v[52:53], v[52:53], s[94:95]
  v_pk_mul_f32 v[54:55], v[54:55], s[94:95]
  v_pk_mul_f32 v[64:65], v[64:65], s[94:95]
  v_pk_mul_f32 v[66:67], v[66:67], s[94:95]
  v_cvt_pk_bf16_f32 v86, v48, v49
  v_cvt_pk_bf16_f32 v87, v50, v51
  v_cvt_pk_bf16_f32 v88, v52, v53
  v_cvt_pk_bf16_f32 v89, v54, v55
  v_cvt_pk_bf16_f32 v90, v64, v65
  v_cvt_pk_bf16_f32 v91, v66, v67
  s_waitcnt lgkmcnt(2)
  ds_write_b128 v14, v[132:135]
  ds_write_b128 v14, v[136:139] offset:1024
  global_store_dwordx4 v14, v[132:135], s[72:73] sc1
  global_store_dwordx4 v14, v[136:139], s[72:73] offset:1024 sc1
  s_waitcnt lgkmcnt(0)
  s_barrier
  s_cmp_lg_u32 s33, 0
  s_cbranch_scc1 L_aux0_300028
  s_cmp_lg_u32 s30, 0
  s_cbranch_scc1 L_ys_300029
  s_lshl_b32 s44, s2, 7
  s_add_u32 s44, s44, 0x24000
  s_add_u32 s45, s31, 32
  v_mov_b32 v4, s44
  v_mov_b32 v5, s45
  s_mov_b32 exec_lo, 0x1
  s_mov_b32 exec_hi, 0x0
  global_store_dword v4, v5, s[26:27] sc1
  s_mov_b64 exec, -1
L_ys_300029:
L_aux0_300028:
  s_mul_i32 s86, s30, 1536
  s_add_u32 s86, s86, 81920
  s_lshl_b32 s87, s30, 11
  s_add_u32 s87, s87, 94208
  s_sub_u32 s44, s86, 4608
  s_sub_u32 s45, s87, 4096
  v_add_u32 v8, s44, v2
  v_add_u32 v9, s44, v3
  v_add_u32 v10, s45, v2
  ds_read_b128 v[70:73], v8 offset:4608
  ds_read_b64 v[74:75], v9 offset:5632
  ds_read_b128 v[56:59], v8 offset:3072
  ds_read_b64 v[60:61], v9 offset:4096
  ds_read_b128 v[62:65], v10 offset:4096
  s_sub_u32 s88, -1, s30
  s_waitcnt lgkmcnt(3)
  v_mfma_f32_32x32x16_bf16 v[16:31], v[70:73], v[80:83], v[208:223]
  v_mfma_f32_32x32x8_bf16 v[16:31], v[74:75], v[84:85], v[16:31]
  s_waitcnt lgkmcnt(1)
  s_nop 8
  s_branch L_attf_300032
L_att_300030:
  s_waitcnt lgkmcnt(1)
  v_mfma_f32_32x32x16_bf16 v[176:191], v[66:69], v[52:55], v[176:191]
L_attf_300032:
  ds_read_b128 v[66:69], v10 offset:5120
  v_exp_f32 v16, v16
  v_exp_f32 v17, v17
  v_exp_f32 v18, v18
  v_exp_f32 v19, v19
  v_cvt_pk_bf16_f32 v48, v16, v17
  v_cvt_pk_bf16_f32 v49, v18, v19
  v_mfma_f32_32x32x16_bf16 v[32:47], v[56:59], v[80:83], 0
  ds_read_b128 v[56:59], v8 offset:1536
  v_exp_f32 v20, v20
  v_exp_f32 v21, v21
  v_exp_f32 v22, v22
  v_exp_f32 v23, v23
  v_cvt_pk_bf16_f32 v50, v20, v21
  v_cvt_pk_bf16_f32 v51, v22, v23
  v_mfma_f32_32x32x8_bf16 v[32:47], v[60:61], v[84:85], v[32:47]
  ds_read_b64 v[60:61], v9 offset:2560
  v_exp_f32 v24, v24
  v_exp_f32 v25, v25
  v_exp_f32 v26, v26
  v_exp_f32 v27, v27
  s_waitcnt lgkmcnt(3)
  v_mfma_f32_32x32x16_bf16 v[176:191], v[62:65], v[48:51], v[176:191]
  ds_read_b128 v[62:65], v10 offset:2048
  v_cvt_pk_bf16_f32 v52, v24, v25
  v_cvt_pk_bf16_f32 v53, v26, v27
  v_exp_f32 v28, v28
  v_exp_f32 v29, v29
  v_exp_f32 v30, v30
  v_exp_f32 v31, v31
  v_cvt_pk_bf16_f32 v54, v28, v29
  v_cvt_pk_bf16_f32 v55, v30, v31
  s_add_u32 s88, s88, 1
  s_cbranch_scc1 L_attx_300031
  s_waitcnt lgkmcnt(1)
  v_mfma_f32_32x32x16_bf16 v[176:191], v[66:69], v[52:55], v[176:191]
  ds_read_b128 v[66:69], v10 offset:3072
  v_exp_f32 v32, v32
  v_exp_f32 v33, v33
  v_exp_f32 v34, v34
  v_exp_f32 v35, v35
  v_cvt_pk_bf16_f32 v48, v32, v33
  v_cvt_pk_bf16_f32 v49, v34, v35
  v_mfma_f32_32x32x16_bf16 v[16:31], v[56:59], v[80:83], 0
  ds_read_b128 v[56:59], v8 offset:0
  v_exp_f32 v36, v36
  v_exp_f32 v37, v37
  v_exp_f32 v38, v38
  v_exp_f32 v39, v39
  v_cvt_pk_bf16_f32 v50, v36, v37
  v_cvt_pk_bf16_f32 v51, v38, v39
  v_mfma_f32_32x32x8_bf16 v[16:31], v[60:61], v[84:85], v[16:31]
  ds_read_b64 v[60:61], v9 offset:1024
  v_exp_f32 v40, v40
  v_exp_f32 v41, v41
  v_exp_f32 v42, v42
  v_exp_f32 v43, v43
  s_waitcnt lgkmcnt(3)
  v_mfma_f32_32x32x16_bf16 v[176:191], v[62:65], v[48:51], v[176:191]
  ds_read_b128 v[62:65], v10 offset:0
  v_cvt_pk_bf16_f32 v52, v40, v41
  v_cvt_pk_bf16_f32 v53, v42, v43
  v_exp_f32 v44, v44
  v_exp_f32 v45, v45
  v_exp_f32 v46, v46
  v_exp_f32 v47, v47
  v_add_u32 v8, 4294964224, v8
  v_add_u32 v9, 4294964224, v9
  v_cvt_pk_bf16_f32 v54, v44, v45
  v_cvt_pk_bf16_f32 v55, v46, v47
  v_add_u32 v10, 4294963200, v10
  s_add_u32 s88, s88, 1
  s_cbranch_scc0 L_att_300030
L_attx_300031:
  s_sub_u32 s46, 7, s30
  s_mul_i32 s86, s46, 1536
  s_add_u32 s86, s86, 81920
  s_lshl_b32 s87, s46, 11
  s_add_u32 s87, s87, 94208
  s_sub_u32 s44, s86, 4608
  s_sub_u32 s45, s87, 4096
  v_add_u32 v8, s44, v2
  v_add_u32 v9, s44, v3
  v_add_u32 v10, s45, v2
  ds_read_b128 v[70:73], v8 offset:4608
  ds_read_b64 v[74:75], v9 offset:5632
  ds_read_b128 v[56:59], v8 offset:3072
  ds_read_b64 v[60:61], v9 offset:4096
  ds_read_b128 v[62:65], v10 offset:4096
  s_sub_u32 s88, s30, 8
  s_waitcnt lgkmcnt(5)
  v_mfma_f32_32x32x16_bf16 v[176:191], v[66:69], v[52:55], v[176:191]
  s_cmp_lg_u32 s33, 0
  s_cbranch_scc1 L_hw_300034
  s_waitcnt vmcnt(0)
  s_branch L_hw_300035
L_hw_300034:
  s_waitcnt vmcnt(0)
L_hw_300035:
  s_mov_b32 exec_lo, 0x1
  s_mov_b32 exec_hi, 0x0
  v_mov_b32 v4, 135104
  v_mov_b32 v5, 1
  ds_add_rtn_u32 v5, v4, v5
  s_waitcnt lgkmcnt(0)
  v_readfirstlane_b32 s44, v5
  s_nop 0
  s_and_b32 s44, s44, 3
  s_cmp_lg_u32 s44, 3
  s_cbranch_scc1 L_hp_300033
  v_mov_b32 v4, s78
  v_mov_b32 v5, s35
  global_store_dword v4, v5, s[26:27] sc1
L_hp_300033:
  s_mov_b64 exec, -1
  s_cmp_lg_u32 s33, 0
  s_cbranch_scc1 L_pt_300036
  v_min_u32 v4, 79, v0
  v_lshlrev_b32 v4, 7, v4
  s_mul_i32 s44, s28, 327680
  s_mul_i32 s45, s29, 10240
  s_add_u32 s44, s44, s45
  s_add_u32 s44, s44, 0x1400000
  v_add_u32 v4, s44, v4
  global_load_dword v230, v4, s[26:27]
L_pt_300036:
  s_waitcnt lgkmcnt(3)
  v_mfma_f32_32x32x16_bf16 v[16:31], v[70:73], v[86:89], v[208:223]
  v_mfma_f32_32x32x8_bf16 v[16:31], v[74:75], v[90:91], v[16:31]
  s_waitcnt lgkmcnt(1)
  s_nop 8
  s_branch L_attf_300039
L_att_300037:
  s_waitcnt lgkmcnt(1)
  v_mfma_f32_32x32x16_bf16 v[192:207], v[66:69], v[52:55], v[192:207]
L_attf_300039:
  ds_read_b128 v[66:69], v10 offset:5120
  v_exp_f32 v16, v16
  v_exp_f32 v17, v17
  v_exp_f32 v18, v18
  v_exp_f32 v19, v19
  v_cvt_pk_bf16_f32 v48, v16, v17
  v_cvt_pk_bf16_f32 v49, v18, v19
  v_mfma_f32_32x32x16_bf16 v[32:47], v[56:59], v[86:89], 0
  ds_read_b128 v[56:59], v8 offset:1536
  v_exp_f32 v20, v20
  v_exp_f32 v21, v21
  v_exp_f32 v22, v22
  v_exp_f32 v23, v23
  v_cvt_pk_bf16_f32 v50, v20, v21
  v_cvt_pk_bf16_f32 v51, v22, v23
  v_mfma_f32_32x32x8_bf16 v[32:47], v[60:61], v[90:91], v[32:47]
  ds_read_b64 v[60:61], v9 offset:2560
  v_exp_f32 v24, v24
  v_exp_f32 v25, v25
  v_exp_f32 v26, v26
  v_exp_f32 v27, v27
  s_waitcnt lgkmcnt(3)
  v_mfma_f32_32x32x16_bf16 v[192:207], v[62:65], v[48:51], v[192:207]
  ds_read_b128 v[62:65], v10 offset:2048
  v_cvt_pk_bf16_f32 v52, v24, v25
  v_cvt_pk_bf16_f32 v53, v26, v27
  v_exp_f32 v28, v28
  v_exp_f32 v29, v29
  v_exp_f32 v30, v30
  v_exp_f32 v31, v31
  v_cvt_pk_bf16_f32 v54, v28, v29
  v_cvt_pk_bf16_f32 v55, v30, v31
  s_add_u32 s88, s88, 1
  s_cbranch_scc1 L_attx_300038
  s_waitcnt lgkmcnt(1)
  v_mfma_f32_32x32x16_bf16 v[192:207], v[66:69], v[52:55], v[192:207]
  ds_read_b128 v[66:69], v10 offset:3072
  v_exp_f32 v32, v32
  v_exp_f32 v33, v33
  v_exp_f32 v34, v34
  v_exp_f32 v35, v35
  v_cvt_pk_bf16_f32 v48, v32, v33
  v_cvt_pk_bf16_f32 v49, v34, v35
  v_mfma_f32_32x32x16_bf16 v[16:31], v[56:59], v[86:89], 0
  ds_read_b128 v[56:59], v8 offset:0
  v_exp_f32 v36, v36
  v_exp_f32 v37, v37
  v_exp_f32 v38, v38
  v_exp_f32 v39, v39
  v_cvt_pk_bf16_f32 v50, v36, v37
  v_cvt_pk_bf16_f32 v51, v38, v39
  v_mfma_f32_32x32x8_bf16 v[16:31], v[60:61], v[90:91], v[16:31]
  ds_read_b64 v[60:61], v9 offset:1024
  v_exp_f32 v40, v40
  v_exp_f32 v41, v41
  v_exp_f32 v42, v42
  v_exp_f32 v43, v43
  s_waitcnt lgkmcnt(3)
  v_mfma_f32_32x32x16_bf16 v[192:207], v[62:65], v[48:51], v[192:207]
  ds_read_b128 v[62:65], v10 offset:0
  v_cvt_pk_bf16_f32 v52, v40, v41
  v_cvt_pk_bf16_f32 v53, v42, v43
  v_exp_f32 v44, v44
  v_exp_f32 v45, v45
  v_exp_f32 v46, v46
  v_exp_f32 v47, v47
  v_add_u32 v8, 4294964224, v8
  v_add_u32 v9, 4294964224, v9
  v_cvt_pk_bf16_f32 v54, v44, v45
  v_cvt_pk_bf16_f32 v55, v46, v47
  v_add_u32 v10, 4294963200, v10
  s_add_u32 s88, s88, 1
  s_cbranch_scc0 L_att_300037
L_attx_300038:
  s_waitcnt lgkmcnt(0)
  v_mfma_f32_32x32x16_bf16 v[192:207], v[66:69], v[52:55], v[192:207]
  s_lshr_b32 s44, s29, 4
  s_and_b32 s45, s29, 15
  s_lshr_b32 s46, s45, 1
  s_cmp_ge_u32 s46, 5
  s_cselect_b32 s49, 1, 0
  s_add_u32 s49, s49, s44
  s_mul_i32 s49, s49, 5
  s_add_u32 s46, s46, s49
  s_lshl_b32 s46, s46, 10
  s_and_b32 s47, s45, 1
  s_lshl_b32 s48, s47, 9
  s_add_u32 s46, s46, s48
  s_mul_i32 s44, s44, 5
  s_lshr_b32 s48, s45, 3
  s_add_u32 s48, s48, s44
  s_add_u32 s48, s48, 13
  s_lshl_b32 s48, s48, 10
  s_bfe_u32 s49, s45, 131073
  s_lshl_b32 s49, s49, 8
  s_add_u32 s48, s48, s49
  s_lshl_b32 s47, s47, 3
  s_add_u32 s48, s48, s47
  v_bfe_u32 v4, v1, 4, 1
  v_mul_u32_u24 v4, 20480, v4
  v_and_b32 v5, 15, v1
  v_lshl_add_u32 v4, v5, 4, v4
  v_lshrrev_b32 v5, 5, v1
  v_lshl_add_u32 v5, v5, 8, v4
  s_mov_b32 s50, s30
  s_mul_i32 s50, s50, 40960
  s_add_u32 s51, s50, s46
  s_add_u32 s50, s50, s48
  v_add_u32 v160, s51, v5
  v_add_u32 v161, s50, v4
  s_sub_u32 s50, 7, s30
  s_mul_i32 s50, s50, 40960
  s_add_u32 s51, s50, s46
  s_add_u32 s50, s50, s48
  v_add_u32 v162, s51, v5
  v_add_u32 v163, s50, v4
  s_cmp_lg_u32 s33, 0
  s_cbranch_scc1 L_l1p_300040
  s_barrier
  v_min_u32 v4, 49, v1
  v_mul_u32_u24 v8, 6554, v4
  v_lshrrev_b32 v8, 16, v8
  v_mul_u32_u24 v9, 10, v8
  v_sub_u32 v9, v4, v9
  s_mul_i32 s45, s30, 80
  v_add_u32 v8, s45, v8
  v_mul_u32_u24 v11, 160, v8
  v_lshl_add_u32 v11, v9, 4, v11
  v_add_u32 v11, 81920, v11
  s_lshr_b32 s44, s30, 1
  v_lshrrev_b32 v12, 4, v1
  v_bfe_u32 v13, v1, 2, 2
  v_and_b32 v16, 3, v1
  v_lshlrev_b32 v16, 3, v16
  v_add_u32 v16, 81920, v16
  v_lshrrev_b32 v17, 1, v12
  v_mul_u32_u24 v17, 20, v17
  v_and_b32 v18, 1, v12
  v_lshl_add_u32 v17, v18, 2, v17
  v_add_u32 v17, v17, v13
  v_mul_u32_u24 v17, 160, v17
  v_add_u32 v17, v17, v16
  v_mul_u32_u24 v18, 40, v12
  v_add3_u32 v18, v18, v13, 16
  v_mul_u32_u24 v18, 160, v18
  v_add_u32 v18, v18, v16
  s_mul_i32 s45, s44, 32000
  v_add_u32 v17, s45, v17
  s_cmp_eq_u32 s44, 0
  s_mov_b32 s48, 25600
  s_mov_b32 s49, 3200
  s_cselect_b32 s46, 6400, s48
  s_cselect_b32 s47, 1280, s49
  s_cselect_b64 s[40:41], -1, 0
  v_add_u32 v19, 19200, v17
  v_cndmask_b32 v19, v18, v19, s[40:41]
  v_add_u32 v20, s47, v19
  v_add_u32 v21, s46, v19
  v_add_u32 v22, s47, v21
  s_mov_b32 exec_lo, 0xffffffff
  s_mov_b32 exec_hi, 0x3ffff
  ds_write_b128 v11, a[64:67] offset:0
  ds_write_b128 v11, a[68:71] offset:800
  ds_write_b128 v11, a[72:75] offset:1600
  ds_write_b128 v11, a[76:79] offset:2400
  ds_write_b128 v11, a[80:83] offset:3200
  ds_write_b128 v11, a[84:87] offset:4000
  ds_write_b128 v11, a[88:91] offset:4800
  ds_write_b128 v11, a[92:95] offset:5600
  ds_write_b128 v11, a[96:99] offset:6400
  ds_write_b128 v11, a[100:103] offset:7200
  ds_write_b128 v11, a[104:107] offset:8000
  ds_write_b128 v11, a[108:111] offset:8800
  ds_write_b128 v11, a[112:115] offset:9600
  ds_write_b128 v11, a[116:119] offset:10400
  ds_write_b128 v11, a[120:123] offset:11200
  ds_write_b128 v11, a[124:127] offset:12000
  s_mov_b64 exec, -1
  s_waitcnt lgkmcnt(0)
  s_barrier
  ds_read_b64_tr_b16 a[0:1], v17 offset:0
  ds_read_b64_tr_b16 a[2:3], v17 offset:1280
  ds_read_b64_tr_b16 a[4:5], v17 offset:32
  ds_read_b64_tr_b16 a[6:7], v17 offset:1312
  ds_read_b64_tr_b16 a[8:9], v17 offset:64
  ds_read_b64_tr_b16 a[10:11], v17 offset:1344
  ds_read_b64_tr_b16 a[12:13], v17 offset:96
  ds_read_b64_tr_b16 a[14:15], v17 offset:1376
  ds_read_b64_tr_b16 a[16:17], v17 offset:128
  ds_read_b64_tr_b16 a[18:19], v17 offset:1408
  ds_read_b64_tr_b16 a[20:21], v17 offset:6400
  ds_read_b64_tr_b16 a[22:23], v17 offset:7680
  ds_read_b64_tr_b16 a[24:25], v17 offset:6432
  ds_read_b64_tr_b16 a[26:27], v17 offset:7712
  s_waitcnt lgkmcnt(9)
  ds_read_b64_tr_b16 a[28:29], v17 offset:6464
  ds_read_b64_tr_b16 a[30:31], v17 offset:7744
  ds_read_b64_tr_b16 a[32:33], v17 offset:6496
  ds_read_b64_tr_b16 a[34:35], v17 offset:7776
  s_waitcnt lgkmcnt(9)
  ds_read_b64_tr_b16 a[36:37], v17 offset:6528
  ds_read_b64_tr_b16 a[38:39], v17 offset:7808
  s_waitcnt lgkmcnt(9)
  ds_read_b64_tr_b16 a[40:41], v17 offset:12800
  ds_read_b64_tr_b16 a[42:43], v17 offset:14080
  ds_read_b64_tr_b16 a[44:45], v17 offset:12832
  ds_read_b64_tr_b16 a[46:47], v17 offset:14112
  s_waitcnt lgkmcnt(9)
  ds_read_b64_tr_b16 a[48:49], v17 offset:12864
  ds_read_b64_tr_b16 a[50:51], v17 offset:14144
  ds_read_b64_tr_b16 a[52:53], v17 offset:12896
  ds_read_b64_tr_b16 a[54:55], v17 offset:14176
  s_waitcnt lgkmcnt(9)
  ds_read_b64_tr_b16 a[56:57], v17 offset:12928
  ds_read_b64_tr_b16 a[58:59], v17 offset:14208
  s_waitcnt lgkmcnt(9)
  ds_read_b64_tr_b16 a[60:61], v19 offset:0
  ds_read_b64_tr_b16 a[62:63], v20 offset:0
  ds_read_b64_tr_b16 a[64:65], v19 offset:32
  ds_read_b64_tr_b16 a[66:67], v20 offset:32
  s_waitcnt lgkmcnt(9)
  ds_read_b64_tr_b16 a[68:69], v19 offset:64
  ds_read_b64_tr_b16 a[70:71], v20 offset:64
  ds_read_b64_tr_b16 a[72:73], v19 offset:96
  ds_read_b64_tr_b16 a[74:75], v20 offset:96
  s_waitcnt lgkmcnt(9)
  ds_read_b64_tr_b16 a[76:77], v19 offset:128
  ds_read_b64_tr_b16 a[78:79], v20 offset:128
  s_waitcnt lgkmcnt(9)
  ds_read_b64_tr_b16 a[80:81], v21 offset:0
  ds_read_b64_tr_b16 a[82:83], v22 offset:0
  ds_read_b64_tr_b16 a[84:85], v21 offset:32
  ds_read_b64_tr_b16 a[86:87], v22 offset:32
  s_waitcnt lgkmcnt(9)
  ds_read_b64_tr_b16 a[88:89], v21 offset:64
  ds_read_b64_tr_b16 a[90:91], v22 offset:64
  ds_read_b64_tr_b16 a[92:93], v21 offset:96
  ds_read_b64_tr_b16 a[94:95], v22 offset:96
  s_waitcnt lgkmcnt(9)
  ds_read_b64_tr_b16 a[96:97], v21 offset:128
  ds_read_b64_tr_b16 a[98:99], v22 offset:128
  s_waitcnt lgkmcnt(0)
  s_barrier
  s_cmp_eq_u32 s28, 0
  s_cbranch_scc1 L_nh_600042
  s_mul_i32 s44, s30, 7168
  v_add_u32 v12, s44, v2
  v_add_u32 v14, 4096, v12
  v_mov_b32 v13, s79
  s_mov_b64 s[46:47], -1
L_poll_600043:
  global_load_dword v4, v13, s[26:27] sc1
  s_cmp_eq_u32 s64, 0
  s_cbranch_scc1 L_polld_600044
  s_sub_u32 s64, s64, 1
  s_waitcnt vmcnt(0)
  v_cmp_ne_u32 vcc, s35, v4
  s_nop 0
  s_and_b64 vcc, vcc, s[46:47]
  s_cbranch_scc1 L_poll_600043
L_polld_600044:
  global_load_dwordx4 v[128:131], v12, s[74:75] offset:0 sc1
  global_load_dwordx4 v[132:135], v12, s[74:75] offset:1024 sc1
  global_load_dwordx4 v[136:139], v12, s[74:75] offset:2048 sc1
  global_load_dwordx4 v[140:143], v12, s[74:75] offset:3072 sc1
  global_load_dwordx4 v[144:147], v14, s[74:75] offset:0 sc1
  global_load_dwordx4 v[148:151], v14, s[74:75] offset:1024 sc1
  global_load_dwordx4 v[152:155], v14, s[74:75] offset:2048 sc1
  v_and_b32 v4, 31, v1
  v_lshrrev_b32 v5, 5, v1
  v_lshlrev_b32 v5, 2, v5
  v_sub_u32 v4, v4, v5
  v_mov_b32 v5, 0xf149f2ca
  v_cmp_le_i32 s[80:81], 0, v4
  v_cmp_le_i32 s[82:83], 1, v4
  s_nop 0
  v_cndmask_b32 v208, 0, v5, s[80:81]
  v_cmp_le_i32 s[84:85], 2, v4
  v_cndmask_b32 v209, 0, v5, s[82:83]
  v_cmp_le_i32 s[86:87], 3, v4
  v_cndmask_b32 v210, 0, v5, s[84:85]
  v_cmp_le_i32 s[80:81], 8, v4
  v_cndmask_b32 v211, 0, v5, s[86:87]
  v_cmp_le_i32 s[82:83], 9, v4
  v_cndmask_b32 v212, 0, v5, s[80:81]
  v_cmp_le_i32 s[84:85], 10, v4
  v_cndmask_b32 v213, 0, v5, s[82:83]
  v_cmp_le_i32 s[86:87], 11, v4
  v_cndmask_b32 v214, 0, v5, s[84:85]
  v_cmp_le_i32 s[80:81], 16, v4
  v_cndmask_b32 v215, 0, v5, s[86:87]
  v_cmp_le_i32 s[82:83], 17, v4
  v_cndmask_b32 v216, 0, v5, s[80:81]
  v_cmp_le_i32 s[84:85], 18, v4
  v_cndmask_b32 v217, 0, v5, s[82:83]
  v_cmp_le_i32 s[86:87], 19, v4
  v_cndmask_b32 v218, 0, v5, s[84:85]
  v_cmp_le_i32 s[80:81], 24, v4
  v_cndmask_b32 v219, 0, v5, s[86:87]
  v_cmp_le_i32 s[82:83], 25, v4
  v_cndmask_b32 v220, 0, v5, s[80:81]
  v_cmp_le_i32 s[84:85], 26, v4
  v_cndmask_b32 v221, 0, v5, s[82:83]
  v_cmp_le_i32 s[86:87], 27, v4
  v_cndmask_b32 v222, 0, v5, s[84:85]
  s_nop 0
  v_cndmask_b32 v223, 0, v5, s[86:87]
L_nh_600042:
  v_lshlrev_b32 v4, 7, v0
  v_add_u32 v4, 147456, v4
  global_load_dword v156, v4, s[26:27] sc1
  s_mov_b32 exec_lo, 0xffffffff
  s_mov_b32 exec_hi, 0x3ffff
  ds_write_b128 v11, a[128:131] offset:0
  ds_write_b128 v11, a[132:135] offset:800
  ds_write_b128 v11, a[136:139] offset:1600
  ds_write_b128 v11, a[140:143] offset:2400
  ds_write_b128 v11, a[144:147] offset:3200
  ds_write_b128 v11, a[148:151] offset:4000
  ds_write_b128 v11, a[152:155] offset:4800
  ds_write_b128 v11, a[156:159] offset:5600
  ds_write_b128 v11, a[160:163] offset:6400
  ds_write_b128 v11, a[164:167] offset:7200
  ds_write_b128 v11, a[168:171] offset:8000
  ds_write_b128 v11, a[172:175] offset:8800
  ds_write_b128 v11, a[176:179] offset:9600
  ds_write_b128 v11, a[180:183] offset:10400
  ds_write_b128 v11, a[184:187] offset:11200
  ds_write_b128 v11, a[188:191] offset:12000
  s_mov_b64 exec, -1
  s_waitcnt lgkmcnt(0)
  s_barrier
  ds_read_b64_tr_b16 a[100:101], v17 offset:0
  ds_read_b64_tr_b16 a[102:103], v17 offset:1280
  ds_read_b64_tr_b16 a[104:105], v17 offset:32
  ds_read_b64_tr_b16 a[106:107], v17 offset:1312
  ds_read_b64_tr_b16 a[108:109], v17 offset:64
  ds_read_b64_tr_b16 a[110:111], v17 offset:1344
  ds_read_b64_tr_b16 a[112:113], v17 offset:96
  ds_read_b64_tr_b16 a[114:115], v17 offset:1376
  ds_read_b64_tr_b16 a[116:117], v17 offset:128
  ds_read_b64_tr_b16 a[118:119], v17 offset:1408
  ds_read_b64_tr_b16 a[120:121], v17 offset:6400
  ds_read_b64_tr_b16 a[122:123], v17 offset:7680
  ds_read_b64_tr_b16 a[124:125], v17 offset:6432
  ds_read_b64_tr_b16 a[126:127], v17 offset:7712
  s_waitcnt lgkmcnt(9)
  ds_read_b64_tr_b16 a[128:129], v17 offset:6464
  ds_read_b64_tr_b16 a[130:131], v17 offset:7744
  ds_read_b64_tr_b16 a[132:133], v17 offset:6496
  ds_read_b64_tr_b16 a[134:135], v17 offset:7776
  s_waitcnt lgkmcnt(9)
  ds_read_b64_tr_b16 a[136:137], v17 offset:6528
  ds_read_b64_tr_b16 a[138:139], v17 offset:7808
  s_waitcnt lgkmcnt(9)
  ds_read_b64_tr_b16 a[140:141], v17 offset:12800
  ds_read_b64_tr_b16 a[142:143], v17 offset:14080
  ds_read_b64_tr_b16 a[144:145], v17 offset:12832
  ds_read_b64_tr_b16 a[146:147], v17 offset:14112
  s_waitcnt lgkmcnt(9)
  ds_read_b64_tr_b16 a[148:149], v17 offset:12864
  ds_read_b64_tr_b16 a[150:151], v17 offset:14144
  ds_read_b64_tr_b16 a[152:153], v17 offset:12896
  ds_read_b64_tr_b16 a[154:155], v17 offset:14176
  s_waitcnt lgkmcnt(9)
  ds_read_b64_tr_b16 a[156:157], v17 offset:12928
  ds_read_b64_tr_b16 a[158:159], v17 offset:14208
  s_waitcnt lgkmcnt(9)
  ds_read_b64_tr_b16 a[160:161], v19 offset:0
  ds_read_b64_tr_b16 a[162:163], v20 offset:0
  ds_read_b64_tr_b16 a[164:165], v19 offset:32
  ds_read_b64_tr_b16 a[166:167], v20 offset:32
  s_waitcnt lgkmcnt(9)
  ds_read_b64_tr_b16 a[168:169], v19 offset:64
  ds_read_b64_tr_b16 a[170:171], v20 offset:64
  ds_read_b64_tr_b16 a[172:173], v19 offset:96
  ds_read_b64_tr_b16 a[174:175], v20 offset:96
  s_waitcnt lgkmcnt(9)
  ds_read_b64_tr_b16 a[176:177], v19 offset:128
  ds_read_b64_tr_b16 a[178:179], v20 offset:128
  s_waitcnt lgkmcnt(9)
  ds_read_b64_tr_b16 a[180:181], v21 offset:0
  ds_read_b64_tr_b16 a[182:183], v22 offset:0
  ds_read_b64_tr_b16 a[184:185], v21 offset:32
  ds_read_b64_tr_b16 a[186:187], v22 offset:32
  s_waitcnt lgkmcnt(9)
  ds_read_b64_tr_b16 a[188:189], v21 offset:64
  ds_read_b64_tr_b16 a[190:191], v22 offset:64
  ds_read_b64_tr_b16 a[192:193], v21 offset:96
  ds_read_b64_tr_b16 a[194:195], v22 offset:96
  s_waitcnt lgkmcnt(9)
  ds_read_b64_tr_b16 a[196:197], v21 offset:128
  ds_read_b64_tr_b16 a[198:199], v22 offset:128
  s_waitcnt lgkmcnt(0)
  s_barrier
  s_waitcnt vmcnt(0)
  s_add_u32 s45, s31, 32
  v_cmp_ne_u32 vcc, s45, v156
  s_nop 0
  s_cmp_eq_u64 vcc, 0
  s_cbranch_scc1 L_yok_600045
  v_lshlrev_b32 v8, 7, v0
  v_add_u32 v8, 147456, v8
  s_mov_b64 s[46:47], -1
L_poll_600046:
  global_load_dword v4, v8, s[26:27] sc1
  s_cmp_eq_u32 s64, 0
  s_cbranch_scc1 L_polld_600047
  s_sub_u32 s64, s64, 1
  s_waitcnt vmcnt(0)
  v_cmp_ne_u32 vcc, s45, v4
  s_nop 0
  s_and_b64 vcc, vcc, s[46:47]
  s_cbranch_scc1 L_poll_600046
L_polld_600047:
L_yok_600045:
  s_cmp_eq_u32 s28, 0
  s_cbranch_scc1 L_nh_600048
  v_add_u32 v9, 135168, v12
  s_waitcnt vmcnt(6)
  ds_write_b128 v9, v[128:131] offset:0
  s_waitcnt vmcnt(5)
  ds_write_b128 v9, v[132:135] offset:1024
  s_waitcnt vmcnt(4)
  ds_write_b128 v9, v[136:139] offset:2048
  s_waitcnt vmcnt(3)
  ds_write_b128 v9, v[140:143] offset:3072
  s_waitcnt vmcnt(2)
  ds_write_b128 v9, v[144:147] offset:4096
  s_waitcnt vmcnt(1)
  ds_write_b128 v9, v[148:151] offset:5120
  s_waitcnt vmcnt(0)
  ds_write_b128 v9, v[152:155] offset:6144
L_nh_600048:
  s_waitcnt lgkmcnt(0)
  s_barrier
  s_cmp_lg_u32 s2, 0
  s_cbranch_scc1 L_nu_600049
  s_cmp_lg_u32 s30, 0
  s_cbranch_scc1 L_nu_600049
  v_mov_b32 v8, 0
  v_mov_b32 v9, s31
  s_mov_b32 exec_lo, 0x1
  s_mov_b32 exec_hi, 0x0
  global_store_dword v8, v9, s[26:27] sc1
  s_mov_b64 exec, -1
L_nu_600049:
  s_lshl_b32 s80, s28, 8
  s_lshl_b32 s81, s29, 3
  s_add_u32 s80, s80, s81
  s_lshl_b32 s80, s80, 1
  s_add_u32 s80, s80, 0x2100000
  v_lshlrev_b32 v8, 12, v0
  v_add_u32 v8, s80, v8
  global_load_dwordx4 v[140:143], v8, s[26:27] sc1
  v_add_u32 v9, 1048576, v8
  global_load_dwordx4 v[144:147], v9, s[26:27] sc1
  v_and_b32 v9, 127, v0
  v_lshlrev_b32 v9, 12, v9
  v_add_u32 v9, s80, v9
  v_add_u32 v9, 2097152, v9
  global_load_dwordx4 v[148:151], v9, s[26:27] sc1
  s_branch L_joined_300041
L_l1p_300040:
  s_cmp_eq_u32 s28, 0
  s_cbranch_scc1 L_joined_300041
  s_mul_i32 s44, s30, 7168
  v_add_u32 v12, s44, v2
  v_add_u32 v14, 4096, v12
  v_mov_b32 v13, s79
  s_mov_b64 s[46:47], -1
L_poll_600050:
  global_load_dword v4, v13, s[26:27] sc1
  s_cmp_eq_u32 s64, 0
  s_cbranch_scc1 L_polld_600051
  s_sub_u32 s64, s64, 1
  s_waitcnt vmcnt(0)
  v_cmp_ne_u32 vcc, s35, v4
  s_nop 0
  s_and_b64 vcc, vcc, s[46:47]
  s_cbranch_scc1 L_poll_600050
L_polld_600051:
  global_load_dwordx4 v[128:131], v12, s[74:75] offset:0 sc1
  global_load_dwordx4 v[132:135], v12, s[74:75] offset:1024 sc1
  global_load_dwordx4 v[136:139], v12, s[74:75] offset:2048 sc1
  global_load_dwordx4 v[140:143], v12, s[74:75] offset:3072 sc1
  global_load_dwordx4 v[144:147], v14, s[74:75] offset:0 sc1
  global_load_dwordx4 v[148:151], v14, s[74:75] offset:1024 sc1
  global_load_dwordx4 v[152:155], v14, s[74:75] offset:2048 sc1
  v_and_b32 v4, 31, v1
  v_lshrrev_b32 v5, 5, v1
  v_lshlrev_b32 v5, 2, v5
  v_sub_u32 v4, v4, v5
  v_mov_b32 v5, 0xf149f2ca
  v_cmp_le_i32 s[80:81], 0, v4
  v_cmp_le_i32 s[82:83], 1, v4
  s_nop 0
  v_cndmask_b32 v208, 0, v5, s[80:81]
  v_cmp_le_i32 s[84:85], 2, v4
  v_cndmask_b32 v209, 0, v5, s[82:83]
  v_cmp_le_i32 s[86:87], 3, v4
  v_cndmask_b32 v210, 0, v5, s[84:85]
  v_cmp_le_i32 s[80:81], 8, v4
  v_cndmask_b32 v211, 0, v5, s[86:87]
  v_cmp_le_i32 s[82:83], 9, v4
  v_cndmask_b32 v212, 0, v5, s[80:81]
  v_cmp_le_i32 s[84:85], 10, v4
  v_cndmask_b32 v213, 0, v5, s[82:83]
  v_cmp_le_i32 s[86:87], 11, v4
  v_cndmask_b32 v214, 0, v5, s[84:85]
  v_cmp_le_i32 s[80:81], 16, v4
  v_cndmask_b32 v215, 0, v5, s[86:87]
  v_cmp_le_i32 s[82:83], 17, v4
  v_cndmask_b32 v216, 0, v5, s[80:81]
  v_cmp_le_i32 s[84:85], 18, v4
  v_cndmask_b32 v217, 0, v5, s[82:83]
  v_cmp_le_i32 s[86:87], 19, v4
  v_cndmask_b32 v218, 0, v5, s[84:85]
  v_cmp_le_i32 s[80:81], 24, v4
  v_cndmask_b32 v219, 0, v5, s[86:87]
  v_cmp_le_i32 s[82:83], 25, v4
  v_cndmask_b32 v220, 0, v5, s[80:81]
  v_cmp_le_i32 s[84:85], 26, v4
  v_cndmask_b32 v221, 0, v5, s[82:83]
  v_cmp_le_i32 s[86:87], 27, v4
  v_cndmask_b32 v222, 0, v5, s[84:85]
  s_nop 0
  v_cndmask_b32 v223, 0, v5, s[86:87]
  v_add_u32 v9, 135168, v12
  s_waitcnt vmcnt(6)
  ds_write_b128 v9, v[128:131] offset:0
  s_waitcnt vmcnt(5)
  ds_write_b128 v9, v[132:135] offset:1024
  s_waitcnt vmcnt(4)
  ds_write_b128 v9, v[136:139] offset:2048
  s_waitcnt vmcnt(3)
  ds_write_b128 v9, v[140:143] offset:3072
  s_waitcnt vmcnt(2)
  ds_write_b128 v9, v[144:147] offset:4096
  s_waitcnt vmcnt(1)
  ds_write_b128 v9, v[148:151] offset:5120
  s_waitcnt vmcnt(0)
  ds_write_b128 v9, v[152:155] offset:6144
  s_waitcnt lgkmcnt(0)
  s_barrier
L_joined_300041:
  s_cmp_eq_u32 s28, 0
  s_cbranch_scc1 L_nohalo_600052
  s_mul_i32 s86, s30, 1536
  s_add_u32 s86, s86, 135168
  s_lshl_b32 s87, s30, 11
  s_add_u32 s87, s87, 147456
  s_mov_b32 s44, s86
  s_mov_b32 s45, s87
  v_add_u32 v8, s44, v2
  v_add_u32 v9, s44, v3
  v_add_u32 v10, s45, v2
  ds_read_b128 v[70:73], v8 offset:0
  ds_read_b64 v[74:75], v9 offset:1024
  ds_read_b128 v[56:59], v8 offset:1536
  ds_read_b64 v[60:61], v9 offset:2560
  ds_read_b128 v[62:65], v10 offset:0
  s_sub_u32 s88, s30, 8
  s_waitcnt lgkmcnt(3)
  v_mfma_f32_32x32x16_bf16 v[16:31], v[70:73], v[80:83], v[208:223]
  v_mfma_f32_32x32x8_bf16 v[16:31], v[74:75], v[84:85], v[16:31]
  s_waitcnt lgkmcnt(1)
  s_nop 8
  s_branch L_attf_600055
L_att_600053:
  s_waitcnt lgkmcnt(1)
  v_mfma_f32_32x32x16_bf16 v[176:191], v[66:69], v[52:55], v[176:191]
L_attf_600055:
  ds_read_b128 v[66:69], v10 offset:1024
  v_exp_f32 v16, v16
  v_exp_f32 v17, v17
  v_exp_f32 v18, v18
  v_exp_f32 v19, v19
  v_cvt_pk_bf16_f32 v48, v16, v17
  v_cvt_pk_bf16_f32 v49, v18, v19
  v_mfma_f32_32x32x16_bf16 v[32:47], v[56:59], v[80:83], 0
  ds_read_b128 v[56:59], v8 offset:3072
  v_exp_f32 v20, v20
  v_exp_f32 v21, v21
  v_exp_f32 v22, v22
  v_exp_f32 v23, v23
  v_cvt_pk_bf16_f32 v50, v20, v21
  v_cvt_pk_bf16_f32 v51, v22, v23
  v_mfma_f32_32x32x8_bf16 v[32:47], v[60:61], v[84:85], v[32:47]
  ds_read_b64 v[60:61], v9 offset:4096
  v_exp_f32 v24, v24
  v_exp_f32 v25, v25
  v_exp_f32 v26, v26
  v_exp_f32 v27, v27
  s_waitcnt lgkmcnt(3)
  v_mfma_f32_32x32x16_bf16 v[176:191], v[62:65], v[48:51], v[176:191]
  ds_read_b128 v[62:65], v10 offset:2048
  v_cvt_pk_bf16_f32 v52, v24, v25
  v_cvt_pk_bf16_f32 v53, v26, v27
  v_exp_f32 v28, v28
  v_exp_f32 v29, v29
  v_exp_f32 v30, v30
  v_exp_f32 v31, v31
  v_cvt_pk_bf16_f32 v54, v28, v29
  v_cvt_pk_bf16_f32 v55, v30, v31
  s_add_u32 s88, s88, 1
  s_cbranch_scc1 L_attx_600054
  s_waitcnt lgkmcnt(1)
  v_mfma_f32_32x32x16_bf16 v[176:191], v[66:69], v[52:55], v[176:191]
  ds_read_b128 v[66:69], v10 offset:3072
  v_exp_f32 v32, v32
  v_exp_f32 v33, v33
  v_exp_f32 v34, v34
  v_exp_f32 v35, v35
  v_cvt_pk_bf16_f32 v48, v32, v33
  v_cvt_pk_bf16_f32 v49, v34, v35
  v_mfma_f32_32x32x16_bf16 v[16:31], v[56:59], v[80:83], 0
  ds_read_b128 v[56:59], v8 offset:4608
  v_exp_f32 v36, v36
  v_exp_f32 v37, v37
  v_exp_f32 v38, v38
  v_exp_f32 v39, v39
  v_cvt_pk_bf16_f32 v50, v36, v37
  v_cvt_pk_bf16_f32 v51, v38, v39
  v_mfma_f32_32x32x8_bf16 v[16:31], v[60:61], v[84:85], v[16:31]
  ds_read_b64 v[60:61], v9 offset:5632
  v_exp_f32 v40, v40
  v_exp_f32 v41, v41
  v_exp_f32 v42, v42
  v_exp_f32 v43, v43
  s_waitcnt lgkmcnt(3)
  v_mfma_f32_32x32x16_bf16 v[176:191], v[62:65], v[48:51], v[176:191]
  ds_read_b128 v[62:65], v10 offset:4096
  v_cvt_pk_bf16_f32 v52, v40, v41
  v_cvt_pk_bf16_f32 v53, v42, v43
  v_exp_f32 v44, v44
  v_exp_f32 v45, v45
  v_exp_f32 v46, v46
  v_exp_f32 v47, v47
  v_add_u32 v8, 3072, v8
  v_add_u32 v9, 3072, v9
  v_cvt_pk_bf16_f32 v54, v44, v45
  v_cvt_pk_bf16_f32 v55, v46, v47
  v_add_u32 v10, 4096, v10
  s_add_u32 s88, s88, 1
  s_cbranch_scc0 L_att_600053
L_attx_600054:
  s_sub_u32 s46, 7, s30
  s_mul_i32 s86, s46, 1536
  s_add_u32 s86, s86, 135168
  s_lshl_b32 s87, s46, 11
  s_add_u32 s87, s87, 147456
  s_mov_b32 s44, s86
  s_mov_b32 s45, s87
  v_add_u32 v8, s44, v2
  v_add_u32 v9, s44, v3
  v_add_u32 v10, s45, v2
  ds_read_b128 v[70:73], v8 offset:0
  ds_read_b64 v[74:75], v9 offset:1024
  ds_read_b128 v[56:59], v8 offset:1536
  ds_read_b64 v[60:61], v9 offset:2560
  ds_read_b128 v[62:65], v10 offset:0
  s_sub_u32 s88, -1, s30
  s_waitcnt lgkmcnt(5)
  v_mfma_f32_32x32x16_bf16 v[176:191], v[66:69], v[52:55], v[176:191]
  s_waitcnt lgkmcnt(3)
  v_mfma_f32_32x32x16_bf16 v[16:31], v[70:73], v[86:89], v[208:223]
  v_mfma_f32_32x32x8_bf16 v[16:31], v[74:75], v[90:91], v[16:31]
  s_waitcnt lgkmcnt(1)
  s_nop 8
  s_branch L_attf_600058
L_att_600056:
  s_waitcnt lgkmcnt(1)
  v_mfma_f32_32x32x16_bf16 v[192:207], v[66:69], v[52:55], v[192:207]
L_attf_600058:
  ds_read_b128 v[66:69], v10 offset:1024
  v_exp_f32 v16, v16
  v_exp_f32 v17, v17
  v_exp_f32 v18, v18
  v_exp_f32 v19, v19
  v_cvt_pk_bf16_f32 v48, v16, v17
  v_cvt_pk_bf16_f32 v49, v18, v19
  v_mfma_f32_32x32x16_bf16 v[32:47], v[56:59], v[86:89], 0
  ds_read_b128 v[56:59], v8 offset:3072
  v_exp_f32 v20, v20
  v_exp_f32 v21, v21
  v_exp_f32 v22, v22
  v_exp_f32 v23, v23
  v_cvt_pk_bf16_f32 v50, v20, v21
  v_cvt_pk_bf16_f32 v51, v22, v23
  v_mfma_f32_32x32x8_bf16 v[32:47], v[60:61], v[90:91], v[32:47]
  ds_read_b64 v[60:61], v9 offset:4096
  v_exp_f32 v24, v24
  v_exp_f32 v25, v25
  v_exp_f32 v26, v26
  v_exp_f32 v27, v27
  s_waitcnt lgkmcnt(3)
  v_mfma_f32_32x32x16_bf16 v[192:207], v[62:65], v[48:51], v[192:207]
  ds_read_b128 v[62:65], v10 offset:2048
  v_cvt_pk_bf16_f32 v52, v24, v25
  v_cvt_pk_bf16_f32 v53, v26, v27
  v_exp_f32 v28, v28
  v_exp_f32 v29, v29
  v_exp_f32 v30, v30
  v_exp_f32 v31, v31
  v_cvt_pk_bf16_f32 v54, v28, v29
  v_cvt_pk_bf16_f32 v55, v30, v31
  s_add_u32 s88, s88, 1
  s_cbranch_scc1 L_attx_600057
  s_waitcnt lgkmcnt(1)
  v_mfma_f32_32x32x16_bf16 v[192:207], v[66:69], v[52:55], v[192:207]
  ds_read_b128 v[66:69], v10 offset:3072
  v_exp_f32 v32, v32
  v_exp_f32 v33, v33
  v_exp_f32 v34, v34
  v_exp_f32 v35, v35
  v_cvt_pk_bf16_f32 v48, v32, v33
  v_cvt_pk_bf16_f32 v49, v34, v35
  v_mfma_f32_32x32x16_bf16 v[16:31], v[56:59], v[86:89], 0
  ds_read_b128 v[56:59], v8 offset:4608
  v_exp_f32 v36, v36
  v_exp_f32 v37, v37
  v_exp_f32 v38, v38
  v_exp_f32 v39, v39
  v_cvt_pk_bf16_f32 v50, v36, v37
  v_cvt_pk_bf16_f32 v51, v38, v39
  v_mfma_f32_32x32x8_bf16 v[16:31], v[60:61], v[90:91], v[16:31]
  ds_read_b64 v[60:61], v9 offset:5632
  v_exp_f32 v40, v40
  v_exp_f32 v41, v41
  v_exp_f32 v42, v42
  v_exp_f32 v43, v43
  s_waitcnt lgkmcnt(3)
  v_mfma_f32_32x32x16_bf16 v[192:207], v[62:65], v[48:51], v[192:207]
  ds_read_b128 v[62:65], v10 offset:4096
  v_cvt_pk_bf16_f32 v52, v40, v41
  v_cvt_pk_bf16_f32 v53, v42, v43
  v_exp_f32 v44, v44
  v_exp_f32 v45, v45
  v_exp_f32 v46, v46
  v_exp_f32 v47, v47
  v_add_u32 v8, 3072, v8
  v_add_u32 v9, 3072, v9
  v_cvt_pk_bf16_f32 v54, v44, v45
  v_cvt_pk_bf16_f32 v55, v46, v47
  v_add_u32 v10, 4096, v10
  s_add_u32 s88, s88, 1
  s_cbranch_scc0 L_att_600056
L_attx_600057:
  s_waitcnt lgkmcnt(0)
  v_mfma_f32_32x32x16_bf16 v[192:207], v[66:69], v[52:55], v[192:207]
L_nohalo_600052:
  s_mov_b32 s44, 0x1f800000
  s_mov_b32 s45, 0x5f800000
  v_cmp_nle_f32 vcc, s44, v188
  v_cmp_nge_f32 s[40:41], s45, v188
  s_nop 0
  s_or_b64 vcc, vcc, s[40:41]
  s_cbranch_scc1 L_fb_600059
L_fbr_600060:
  s_nop 4
  v_cmp_nle_f32 vcc, s44, v204
  v_cmp_nge_f32 s[40:41], s45, v204
  s_nop 0
  s_or_b64 vcc, vcc, s[40:41]
  s_cbranch_scc1 L_fb_600061
L_fbr_600062:
  v_rcp_f32 v8, v188
  v_rcp_f32 v10, v204
  v_mov_b32 v9, v8
  v_mov_b32 v11, v10
  v_pk_mul_f32 v[176:177], v[176:177], v[8:9]
  v_pk_mul_f32 v[178:179], v[178:179], v[8:9]
  v_pk_mul_f32 v[180:181], v[180:181], v[8:9]
  v_pk_mul_f32 v[182:183], v[182:183], v[8:9]
  v_pk_mul_f32 v[184:185], v[184:185], v[8:9]
  v_pk_mul_f32 v[186:187], v[186:187], v[8:9]
  v_cvt_pk_bf16_f32 v48, v176, v177
  v_cvt_pk_bf16_f32 v49, v178, v179
  v_cvt_pk_bf16_f32 v50, v180, v181
  v_cvt_pk_bf16_f32 v51, v182, v183
  v_cvt_pk_bf16_f32 v52, v184, v185
  v_cvt_pk_bf16_f32 v53, v186, v187
  v_pk_mul_f32 v[192:193], v[192:193], v[10:11]
  v_pk_mul_f32 v[194:195], v[194:195], v[10:11]
  v_pk_mul_f32 v[196:197], v[196:197], v[10:11]
  v_pk_mul_f32 v[198:199], v[198:199], v[10:11]
  v_pk_mul_f32 v[200:201], v[200:201], v[10:11]
  v_pk_mul_f32 v[202:203], v[202:203], v[10:11]
  v_cvt_pk_bf16_f32 v56, v192, v193
  v_cvt_pk_bf16_f32 v57, v194, v195
  v_cvt_pk_bf16_f32 v58, v196, v197
  v_cvt_pk_bf16_f32 v59, v198, v199
  v_cvt_pk_bf16_f32 v60, v200, v201
  v_cvt_pk_bf16_f32 v61, v202, v203
  s_cmp_lg_u32 s32, 0
  s_cbranch_scc1 L_slow_600063
  global_store_dwordx4 v160, v[48:51], s[68:69]
  s_mov_b32 exec_lo, 0xffffffff
  s_mov_b32 exec_hi, 0x0
  global_store_dwordx2 v161, v[52:53], s[68:69]
  s_mov_b64 exec, -1
  global_store_dwordx4 v162, v[56:59], s[68:69]
  s_mov_b32 exec_lo, 0xffffffff
  s_mov_b32 exec_hi, 0x0
  global_store_dwordx2 v163, v[60:61], s[68:69]
  s_mov_b64 exec, -1
L_stj_600064:
  s_add_u32 s44, s34, 1
  v_mov_b32 v5, s44
  s_waitcnt vmcnt(0)
  s_barrier
  s_cmp_lg_u32 s30, 0
  s_cbranch_scc1 L_sig_600065
  s_mov_b32 exec_lo, 0x1
  s_mov_b32 exec_hi, 0x0
  s_cmp_lg_u32 s32, 0
  s_cbranch_scc1 L_slow_600066
  global_store_dword v6, v5, s[58:59]
L_stj_600067:
  s_mov_b64 exec, -1
L_sig_600065:
  s_cmp_lg_u32 s33, 0
  s_cbranch_scc1 L_aux2_600068
  v_and_b32 v10, 7, v0
  v_mul_u32_u24 v10, 320, v10
  v_lshrrev_b32 v11, 3, v0
  v_lshl_add_u32 v10, v11, 2, v10
  v_add_u32 v10, 118784, v10
  ds_write_b32 v10, v140 offset:0
  ds_write_b32 v10, v141 offset:2560
  ds_write_b32 v10, v142 offset:5120
  ds_write_b32 v10, v143 offset:7680
  ds_write_b32 v10, v144 offset:128
  ds_write_b32 v10, v145 offset:2688
  ds_write_b32 v10, v146 offset:5248
  ds_write_b32 v10, v147 offset:7808
  s_cmp_ge_u32 s30, 2
  s_cbranch_scc1 L_yl_600069
  ds_write_b32 v10, v148 offset:256
  ds_write_b32 v10, v149 offset:2816
  ds_write_b32 v10, v150 offset:5376
  ds_write_b32 v10, v151 offset:7936
L_yl_600069:
  s_mul_i32 s80, s30, 2560
  s_add_u32 s80, s80, 118784
  v_bfe_u32 v10, v1, 2, 2
  v_mul_u32_u24 v10, 320, v10
  v_lshrrev_b32 v11, 4, v1
  v_lshl_add_u32 v10, v11, 5, v10
  v_and_b32 v11, 3, v1
  v_lshl_add_u32 v10, v11, 3, v10
  v_add_u32 v10, s80, v10
  s_waitcnt lgkmcnt(0)
  s_barrier
  ds_read_b64_tr_b16 v[244:245], v10 offset:0
  ds_read_b64_tr_b16 v[246:247], v10 offset:1280
  ds_read_b64_tr_b16 v[248:249], v10 offset:128
  ds_read_b64_tr_b16 v[250:251], v10 offset:1408
  ds_read_b64_tr_b16 v[252:253], v10 offset:256
  ds_read_b64_tr_b16 v[254:255], v10 offset:1536
  s_waitcnt lgkmcnt(0)
  s_mov_b32 exec_lo, 0x0
  s_mov_b32 exec_hi, 0xffffffff
  v_mov_b32 v252, 0
  v_mov_b32 v253, 0
  v_mov_b32 v254, 0
  v_mov_b32 v255, 0
  s_mov_b64 exec, -1
L_aux2_600068:
  s_lshr_b32 s80, s29, 3
  s_lshl_b32 s80, s80, 2
  s_and_b32 s81, s30, 1
  s_lshl_b32 s81, s81, 1
  s_add_u32 s80, s80, s81
  s_lshr_b32 s81, s30, 1
  s_add_u32 s82, s80, s81
  s_xor_b32 s83, s82, 1
  s_mul_i32 s84, s81, 10240
  s_mul_i32 s85, s82, 20480
  s_add_u32 s85, s85, s84
  v_add_u32 v8, s85, v2
  s_mul_i32 s85, s83, 20480
  s_add_u32 s85, s85, s84
  v_add_u32 v9, s85, v2
  s_mul_i32 s85, s30, 5120
  s_add_u32 s85, s85, 81920
  v_add_u32 v10, s85, v2
  s_xor_b32 s85, s30, 2
  s_mul_i32 s85, s85, 5120
  s_add_u32 s85, s85, 81920
  v_add_u32 v11, s85, v2
  s_lshl_b32 s85, s82, 1
  s_mul_i32 s85, s85, 10240
  s_and_b32 s86, s29, 7
  s_mul_i32 s86, s86, 1280
  s_add_u32 s85, s85, s86
  v_bfe_u32 v12, v1, 3, 1
  v_mul_u32_u24 v12, 10240, v12
  v_and_b32 v13, 7, v1
  v_lshl_add_u32 v12, v13, 4, v12
  v_bfe_u32 v13, v1, 4, 1
  v_lshl_add_u32 v12, v13, 8, v12
  v_lshrrev_b32 v13, 5, v1
  v_lshl_add_u32 v12, v13, 7, v12
  v_add_u32 v12, s85, v12
  v_mov_b32 v66, 0
  v_mov_b32 v67, 0
  v_add_u32 v68, 4096, v8
  v_add_u32 v70, 8192, v8
  v_add_u32 v69, 4096, v9
  v_add_u32 v71, 8192, v9
  s_lshr_b32 s85, s82, 1
  s_mul_i32 s85, s85, 40960
  s_and_b32 s86, s82, 1
  s_lshl_b32 s86, s86, 8
  s_add_u32 s85, s85, s86
  s_and_b32 s86, s29, 7
  s_mul_i32 s86, s86, 5120
  s_add_u32 s85, s85, s86
  v_bfe_u32 v12, v1, 3, 1
  v_lshlrev_b32 v12, 7, v12
  v_and_b32 v13, 7, v1
  v_lshl_add_u32 v12, v13, 4, v12
  v_bfe_u32 v13, v1, 4, 1
  v_lshl_add_u32 v12, v13, 10, v12
  v_lshrrev_b32 v13, 5, v1
  v_lshl_add_u32 v12, v13, 9, v12
  v_add_u32 v12, s85, v12
  v_add_u32 v13, 4096, v12
  s_add_u32 s52, s34, 1
L_poll_600070:
  global_load_dword v4, v15, s[58:59] sc1
  s_cmp_eq_u32 s64, 0
  s_cbranch_scc1 L_polld_600071
  s_sub_u32 s64, s64, 1
  s_waitcnt vmcnt(0)
  v_cmp_ne_u32 vcc, s52, v4
  s_nop 0
  s_and_b64 vcc, vcc, s[6:7]
  s_cbranch_scc1 L_poll_600070
L_polld_600071:
  global_load_dwordx4 v[100:103], v9, s[68:69] offset:0 sc1
  global_load_dwordx4 v[96:99], v8, s[68:69] offset:0 sc1
  global_load_dwordx4 v[108:111], v9, s[68:69] offset:1024 sc1
  global_load_dwordx4 v[104:107], v8, s[68:69] offset:1024 sc1
  global_load_dwordx4 v[116:119], v9, s[68:69] offset:2048 sc1
  global_load_dwordx4 v[112:115], v8, s[68:69] offset:2048 sc1
  global_load_dwordx4 v[124:127], v9, s[68:69] offset:3072 sc1
  global_load_dwordx4 v[120:123], v8, s[68:69] offset:3072 sc1
  s_waitcnt vmcnt(7)
  v_mfma_f32_16x16x32_bf16 v[36:39], a[0:3], v[100:103], 0
  v_mfma_f32_16x16x32_bf16 v[40:43], a[4:7], v[100:103], 0
  global_load_dwordx4 v[132:135], v69, s[68:69] offset:0 sc1
  v_mfma_f32_16x16x32_bf16 v[44:47], a[8:11], v[100:103], 0
  v_mfma_f32_16x16x32_bf16 v[48:51], a[12:15], v[100:103], 0
  v_mfma_f32_16x16x32_bf16 v[52:55], a[16:19], v[100:103], 0
  s_waitcnt vmcnt(7)
  v_mfma_f32_16x16x32_bf16 v[16:19], a[0:3], v[96:99], 0
  v_mfma_f32_16x16x32_bf16 v[20:23], a[4:7], v[96:99], 0
  global_load_dwordx4 v[128:131], v68, s[68:69] offset:0 sc1
  v_mfma_f32_16x16x32_bf16 v[24:27], a[8:11], v[96:99], 0
  v_mfma_f32_16x16x32_bf16 v[28:31], a[12:15], v[96:99], 0
  v_mfma_f32_16x16x32_bf16 v[32:35], a[16:19], v[96:99], 0
  s_waitcnt vmcnt(7)
  v_mfma_f32_16x16x32_bf16 v[36:39], a[20:23], v[108:111], v[36:39]
  v_mfma_f32_16x16x32_bf16 v[40:43], a[24:27], v[108:111], v[40:43]
  global_load_dwordx4 v[140:143], v69, s[68:69] offset:1024 sc1
  v_mfma_f32_16x16x32_bf16 v[44:47], a[28:31], v[108:111], v[44:47]
  v_mfma_f32_16x16x32_bf16 v[48:51], a[32:35], v[108:111], v[48:51]
  v_mfma_f32_16x16x32_bf16 v[52:55], a[36:39], v[108:111], v[52:55]
  s_waitcnt vmcnt(7)
  v_mfma_f32_16x16x32_bf16 v[16:19], a[20:23], v[104:107], v[16:19]
  v_mfma_f32_16x16x32_bf16 v[20:23], a[24:27], v[104:107], v[20:23]
  global_load_dwordx4 v[136:139], v68, s[68:69] offset:1024 sc1
  v_mfma_f32_16x16x32_bf16 v[24:27], a[28:31], v[104:107], v[24:27]
  v_mfma_f32_16x16x32_bf16 v[28:31], a[32:35], v[104:107], v[28:31]
  v_mfma_f32_16x16x32_bf16 v[32:35], a[36:39], v[104:107], v[32:35]
  s_waitcnt vmcnt(7)
  v_mfma_f32_16x16x32_bf16 v[36:39], a[40:43], v[116:119], v[36:39]
  v_mfma_f32_16x16x32_bf16 v[40:43], a[44:47], v[116:119], v[40:43]
  global_load_dwordx4 v[148:151], v69, s[68:69] offset:2048 sc1
  v_mfma_f32_16x16x32_bf16 v[44:47], a[48:51], v[116:119], v[44:47]
  v_mfma_f32_16x16x32_bf16 v[48:51], a[52:55], v[116:119], v[48:51]
  v_mfma_f32_16x16x32_bf16 v[52:55], a[56:59], v[116:119], v[52:55]
  s_waitcnt vmcnt(7)
  v_mfma_f32_16x16x32_bf16 v[16:19], a[40:43], v[112:115], v[16:19]
  v_mfma_f32_16x16x32_bf16 v[20:23], a[44:47], v[112:115], v[20:23]
  global_load_dwordx4 v[144:147], v68, s[68:69] offset:2048 sc1
  v_mfma_f32_16x16x32_bf16 v[24:27], a[48:51], v[112:115], v[24:27]
  v_mfma_f32_16x16x32_bf16 v[28:31], a[52:55], v[112:115], v[28:31]
  v_mfma_f32_16x16x32_bf16 v[32:35], a[56:59], v[112:115], v[32:35]
  s_waitcnt vmcnt(7)
  v_mfma_f32_16x16x32_bf16 v[36:39], a[60:63], v[124:127], v[36:39]
  v_mfma_f32_16x16x32_bf16 v[40:43], a[64:67], v[124:127], v[40:43]
  global_load_dwordx4 v[156:159], v69, s[68:69] offset:3072 sc1
  v_mfma_f32_16x16x32_bf16 v[44:47], a[68:71], v[124:127], v[44:47]
  v_mfma_f32_16x16x32_bf16 v[48:51], a[72:75], v[124:127], v[48:51]
  v_mfma_f32_16x16x32_bf16 v[52:55], a[76:79], v[124:127], v[52:55]
  s_waitcnt vmcnt(7)
  v_mfma_f32_16x16x32_bf16 v[16:19], a[60:63], v[120:123], v[16:19]
  v_mfma_f32_16x16x32_bf16 v[20:23], a[64:67], v[120:123], v[20:23]
  global_load_dwordx4 v[152:155], v68, s[68:69] offset:3072 sc1
  v_mfma_f32_16x16x32_bf16 v[24:27], a[68:71], v[120:123], v[24:27]
  v_mfma_f32_16x16x32_bf16 v[28:31], a[72:75], v[120:123], v[28:31]
  v_mfma_f32_16x16x32_bf16 v[32:35], a[76:79], v[120:123], v[32:35]
  s_waitcnt vmcnt(7)
  v_mfma_f32_16x16x32_bf16 v[36:39], a[80:83], v[132:135], v[36:39]
  v_mfma_f32_16x16x32_bf16 v[40:43], a[84:87], v[132:135], v[40:43]
  global_load_dwordx4 v[164:167], v71, s[68:69] offset:0 sc1
  v_mfma_f32_16x16x32_bf16 v[44:47], a[88:91], v[132:135], v[44:47]
  v_mfma_f32_16x16x32_bf16 v[48:51], a[92:95], v[132:135], v[48:51]
  v_mfma_f32_16x16x32_bf16 v[52:55], a[96:99], v[132:135], v[52:55]
  s_waitcnt vmcnt(7)
  v_mfma_f32_16x16x32_bf16 v[16:19], a[80:83], v[128:131], v[16:19]
  v_mfma_f32_16x16x32_bf16 v[20:23], a[84:87], v[128:131], v[20:23]
  global_load_dwordx4 v[160:163], v70, s[68:69] offset:0 sc1
  v_mfma_f32_16x16x32_bf16 v[24:27], a[88:91], v[128:131], v[24:27]
  v_mfma_f32_16x16x32_bf16 v[28:31], a[92:95], v[128:131], v[28:31]
  v_mfma_f32_16x16x32_bf16 v[32:35], a[96:99], v[128:131], v[32:35]
  s_waitcnt vmcnt(7)
  v_mfma_f32_16x16x32_bf16 v[36:39], a[100:103], v[140:143], v[36:39]
  v_mfma_f32_16x16x32_bf16 v[40:43], a[104:107], v[140:143], v[40:43]
  global_load_dwordx4 v[172:175], v71, s[68:69] offset:1024 sc1
  v_mfma_f32_16x16x32_bf16 v[44:47], a[108:111], v[140:143], v[44:47]
  v_mfma_f32_16x16x32_bf16 v[48:51], a[112:115], v[140:143], v[48:51]
  v_mfma_f32_16x16x32_bf16 v[52:55], a[116:119], v[140:143], v[52:55]
  s_waitcnt vmcnt(7)
  v_mfma_f32_16x16x32_bf16 v[16:19], a[100:103], v[136:139], v[16:19]
  v_mfma_f32_16x16x32_bf16 v[20:23], a[104:107], v[136:139], v[20:23]
  global_load_dwordx4 v[168:171], v70, s[68:69] offset:1024 sc1
  v_mfma_f32_16x16x32_bf16 v[24:27], a[108:111], v[136:139], v[24:27]
  v_mfma_f32_16x16x32_bf16 v[28:31], a[112:115], v[136:139], v[28:31]
  v_mfma_f32_16x16x32_bf16 v[32:35], a[116:119], v[136:139], v[32:35]
  s_waitcnt vmcnt(7)
  v_mfma_f32_16x16x32_bf16 v[36:39], a[120:123], v[148:151], v[36:39]
  v_mfma_f32_16x16x32_bf16 v[40:43], a[124:127], v[148:151], v[40:43]
  v_mfma_f32_16x16x32_bf16 v[44:47], a[128:131], v[148:151], v[44:47]
  v_mfma_f32_16x16x32_bf16 v[48:51], a[132:135], v[148:151], v[48:51]
  v_mfma_f32_16x16x32_bf16 v[52:55], a[136:139], v[148:151], v[52:55]
  s_waitcnt vmcnt(6)
  v_mfma_f32_16x16x32_bf16 v[16:19], a[120:123], v[144:147], v[16:19]
  v_mfma_f32_16x16x32_bf16 v[20:23], a[124:127], v[144:147], v[20:23]
  v_mfma_f32_16x16x32_bf16 v[24:27], a[128:131], v[144:147], v[24:27]
  v_mfma_f32_16x16x32_bf16 v[28:31], a[132:135], v[144:147], v[28:31]
  v_mfma_f32_16x16x32_bf16 v[32:35], a[136:139], v[144:147], v[32:35]
  s_waitcnt vmcnt(5)
  v_mfma_f32_16x16x32_bf16 v[36:39], a[140:143], v[156:159], v[36:39]
  v_mfma_f32_16x16x32_bf16 v[40:43], a[144:147], v[156:159], v[40:43]
  v_mfma_f32_16x16x32_bf16 v[44:47], a[148:151], v[156:159], v[44:47]
  v_mfma_f32_16x16x32_bf16 v[48:51], a[152:155], v[156:159], v[48:51]
  v_mfma_f32_16x16x32_bf16 v[52:55], a[156:159], v[156:159], v[52:55]
  s_waitcnt vmcnt(4)
  v_mfma_f32_16x16x32_bf16 v[16:19], a[140:143], v[152:155], v[16:19]
  v_mfma_f32_16x16x32_bf16 v[20:23], a[144:147], v[152:155], v[20:23]
  v_mfma_f32_16x16x32_bf16 v[24:27], a[148:151], v[152:155], v[24:27]
  v_mfma_f32_16x16x32_bf16 v[28:31], a[152:155], v[152:155], v[28:31]
  v_mfma_f32_16x16x32_bf16 v[32:35], a[156:159], v[152:155], v[32:35]
  s_waitcnt vmcnt(3)
  v_mfma_f32_16x16x32_bf16 v[36:39], a[160:163], v[164:167], v[36:39]
  v_mfma_f32_16x16x32_bf16 v[40:43], a[164:167], v[164:167], v[40:43]
  v_mfma_f32_16x16x32_bf16 v[44:47], a[168:171], v[164:167], v[44:47]
  v_mfma_f32_16x16x32_bf16 v[48:51], a[172:175], v[164:167], v[48:51]
  v_mfma_f32_16x16x32_bf16 v[52:55], a[176:179], v[164:167], v[52:55]
  s_waitcnt vmcnt(2)
  v_mfma_f32_16x16x32_bf16 v[16:19], a[160:163], v[160:163], v[16:19]
  v_mfma_f32_16x16x32_bf16 v[20:23], a[164:167], v[160:163], v[20:23]
  v_mfma_f32_16x16x32_bf16 v[24:27], a[168:171], v[160:163], v[24:27]
  v_mfma_f32_16x16x32_bf16 v[28:31], a[172:175], v[160:163], v[28:31]
  v_mfma_f32_16x16x32_bf16 v[32:35], a[176:179], v[160:163], v[32:35]
  s_waitcnt vmcnt(1)
  v_mfma_f32_16x16x32_bf16 v[36:39], a[180:183], v[172:175], v[36:39]
  v_mfma_f32_16x16x32_bf16 v[40:43], a[184:187], v[172:175], v[40:43]
  v_mfma_f32_16x16x32_bf16 v[44:47], a[188:191], v[172:175], v[44:47]
  v_mfma_f32_16x16x32_bf16 v[48:51], a[192:195], v[172:175], v[48:51]
  v_mfma_f32_16x16x32_bf16 v[52:55], a[196:199], v[172:175], v[52:55]
  s_waitcnt vmcnt(0)
  v_mfma_f32_16x16x32_bf16 v[16:19], a[180:183], v[168:171], v[16:19]
  v_mfma_f32_16x16x32_bf16 v[20:23], a[184:187], v[168:171], v[20:23]
  v_mfma_f32_16x16x32_bf16 v[24:27], a[188:191], v[168:171], v[24:27]
  v_mfma_f32_16x16x32_bf16 v[28:31], a[192:195], v[168:171], v[28:31]
  v_mfma_f32_16x16x32_bf16 v[32:35], a[196:199], v[168:171], v[32:35]
  ds_write_b128 v10, v[36:39] offset:0
  ds_write_b128 v10, v[40:43] offset:1024
  ds_write_b128 v10, v[44:47] offset:2048
  ds_write_b128 v10, v[48:51] offset:3072
  ds_write_b128 v10, v[52:55] offset:4096
  s_waitcnt lgkmcnt(0)
  s_barrier
  ds_read_b128 v[96:99], v11 offset:0
  ds_read_b128 v[100:103], v11 offset:1024
  ds_read_b128 v[104:107], v11 offset:2048
  ds_read_b128 v[108:111], v11 offset:3072
  ds_read_b128 v[112:115], v11 offset:4096
  s_waitcnt lgkmcnt(4)
  v_pk_add_f32 v[16:17], v[16:17], v[96:97]
  v_pk_add_f32 v[18:19], v[18:19], v[98:99]
  v_cvt_pk_bf16_f32 v56, v16, v17
  v_cvt_pk_bf16_f32 v57, v18, v19
  s_waitcnt lgkmcnt(3)
  v_pk_add_f32 v[20:21], v[20:21], v[100:101]
  v_pk_add_f32 v[22:23], v[22:23], v[102:103]
  v_cvt_pk_bf16_f32 v58, v20, v21
  v_cvt_pk_bf16_f32 v59, v22, v23
  s_waitcnt lgkmcnt(2)
  v_pk_add_f32 v[24:25], v[24:25], v[104:105]
  v_pk_add_f32 v[26:27], v[26:27], v[106:107]
  v_cvt_pk_bf16_f32 v60, v24, v25
  v_cvt_pk_bf16_f32 v61, v26, v27
  s_waitcnt lgkmcnt(1)
  v_pk_add_f32 v[28:29], v[28:29], v[108:109]
  v_pk_add_f32 v[30:31], v[30:31], v[110:111]
  v_cvt_pk_bf16_f32 v62, v28, v29
  v_cvt_pk_bf16_f32 v63, v30, v31
  s_waitcnt lgkmcnt(0)
  v_pk_add_f32 v[32:33], v[32:33], v[112:113]
  v_pk_add_f32 v[34:35], v[34:35], v[114:115]
  v_cvt_pk_bf16_f32 v64, v32, v33
  v_cvt_pk_bf16_f32 v65, v34, v35
  v_permlane16_swap_b32 v56, v58
  v_permlane16_swap_b32 v57, v59
  v_permlane16_swap_b32 v60, v62
  v_permlane16_swap_b32 v61, v63
  v_permlane16_swap_b32 v64, v66
  v_permlane16_swap_b32 v65, v67
  s_cmp_lg_u32 s32, 0
  s_cbranch_scc1 L_slow_600072
  global_store_dwordx4 v12, v[56:59], s[66:67]
  global_store_dwordx4 v12, v[60:63], s[66:67] offset:2048
  s_mov_b32 exec_lo, 0xffff
  s_mov_b32 exec_hi, 0xffff
  global_store_dwordx4 v13, v[64:67], s[66:67]
  s_mov_b64 exec, -1
L_stj_600073:
  s_add_u32 s44, s34, 2
  v_mov_b32 v5, s44
  s_waitcnt vmcnt(0)
  s_barrier
  s_cmp_lg_u32 s30, 0
  s_cbranch_scc1 L_sig_600074
  s_mov_b32 exec_lo, 0x1
  s_mov_b32 exec_hi, 0x0
  s_cmp_lg_u32 s32, 0
  s_cbranch_scc1 L_slow_600075
  global_store_dword v6, v5, s[60:61]
L_stj_600076:
  s_mov_b64 exec, -1
L_sig_600074:
  s_lshr_b32 s44, s29, 2
  s_mul_i32 s44, s44, 40960
  s_and_b32 s45, s29, 3
  s_lshl_b32 s45, s45, 7
  s_add_u32 s44, s44, s45
  s_lshl_b32 s45, s30, 5
  s_add_u32 s44, s44, s45
  v_lshrrev_b32 v8, 1, v1
  v_lshlrev_b32 v8, 9, v8
  v_and_b32 v9, 1, v1
  v_lshlrev_b32 v9, 4, v9
  v_add3_u32 v8, v8, v9, s44
  v_add_u32 v9, 16384, v8
  v_add_u32 v10, 32768, v8
  v_mov_b32 v104, 0
  v_mov_b32 v105, 0
  v_mov_b32 v106, 0
  v_mov_b32 v107, 0
  v_lshlrev_b32 v16, 16, v232
  v_and_b32 v17, 0xffff0000, v232
  v_lshlrev_b32 v18, 16, v233
  v_and_b32 v19, 0xffff0000, v233
  v_lshlrev_b32 v20, 16, v234
  v_and_b32 v21, 0xffff0000, v234
  v_lshlrev_b32 v22, 16, v235
  v_and_b32 v23, 0xffff0000, v235
  v_lshlrev_b32 v24, 16, v236
  v_and_b32 v25, 0xffff0000, v236
  v_lshlrev_b32 v26, 16, v237
  v_and_b32 v27, 0xffff0000, v237
  v_lshlrev_b32 v28, 16, v238
  v_and_b32 v29, 0xffff0000, v238
  v_lshlrev_b32 v30, 16, v239
  v_and_b32 v31, 0xffff0000, v239
  v_lshlrev_b32 v32, 16, v240
  v_and_b32 v33, 0xffff0000, v240
  v_lshlrev_b32 v34, 16, v241
  v_and_b32 v35, 0xffff0000, v241
  v_lshlrev_b32 v36, 16, v242
  v_and_b32 v37, 0xffff0000, v242
  v_lshlrev_b32 v38, 16, v243
  v_and_b32 v39, 0xffff0000, v243
  v_lshlrev_b32 v136, 16, v244
  v_and_b32 v137, 0xffff0000, v244
  v_lshlrev_b32 v138, 16, v245
  v_and_b32 v139, 0xffff0000, v245
  v_lshlrev_b32 v140, 16, v246
  v_and_b32 v141, 0xffff0000, v246
  v_lshlrev_b32 v142, 16, v247
  v_and_b32 v143, 0xffff0000, v247
  v_lshlrev_b32 v144, 16, v248
  v_and_b32 v145, 0xffff0000, v248
  v_lshlrev_b32 v146, 16, v249
  v_and_b32 v147, 0xffff0000, v249
  v_lshlrev_b32 v148, 16, v250
  v_and_b32 v149, 0xffff0000, v250
  v_lshlrev_b32 v150, 16, v251
  v_and_b32 v151, 0xffff0000, v251
  v_lshlrev_b32 v152, 16, v252
  v_and_b32 v153, 0xffff0000, v252
  v_lshlrev_b32 v154, 16, v253
  v_and_b32 v155, 0xffff0000, v253
  v_lshlrev_b32 v156, 16, v254
  v_and_b32 v157, 0xffff0000, v254
  v_lshlrev_b32 v158, 16, v255
  v_and_b32 v159, 0xffff0000, v255
  s_add_u32 s52, s34, 2
L_poll_600077:
  global_load_dword v4, v15, s[60:61] sc1
  s_cmp_eq_u32 s64, 0
  s_cbranch_scc1 L_polld_600078
  s_sub_u32 s64, s64, 1
  s_waitcnt vmcnt(0)
  v_cmp_ne_u32 vcc, s52, v4
  s_nop 0
  s_and_b64 vcc, vcc, s[10:11]
  s_cbranch_scc1 L_poll_600077
L_polld_600078:
  global_load_dwordx4 v[96:99], v8, s[66:67] sc1
  global_load_dwordx4 v[100:103], v9, s[66:67] sc1
  s_mov_b32 exec_lo, 0xffffffff
  s_mov_b32 exec_hi, 0x0
  global_load_dwordx4 v[104:107], v10, s[66:67] sc1
  s_mov_b64 exec, -1
  s_waitcnt vmcnt(2)
  v_lshlrev_b32 v64, 16, v96
  v_and_b32 v65, 0xffff0000, v96
  v_lshlrev_b32 v66, 16, v97
  v_and_b32 v67, 0xffff0000, v97
  v_lshlrev_b32 v68, 16, v98
  v_and_b32 v69, 0xffff0000, v98
  v_lshlrev_b32 v70, 16, v99
  v_and_b32 v71, 0xffff0000, v99
  v_pk_add_f32 v[16:17], v[16:17], v[64:65]
  v_pk_add_f32 v[18:19], v[18:19], v[66:67]
  v_pk_add_f32 v[20:21], v[20:21], v[68:69]
  v_pk_add_f32 v[22:23], v[22:23], v[70:71]
  s_waitcnt vmcnt(1)
  v_lshlrev_b32 v72, 16, v100
  v_and_b32 v73, 0xffff0000, v100
  v_lshlrev_b32 v74, 16, v101
  v_and_b32 v75, 0xffff0000, v101
  v_lshlrev_b32 v76, 16, v102
  v_and_b32 v77, 0xffff0000, v102
  v_lshlrev_b32 v78, 16, v103
  v_and_b32 v79, 0xffff0000, v103
  v_pk_add_f32 v[24:25], v[24:25], v[72:73]
  v_pk_add_f32 v[26:27], v[26:27], v[74:75]
  v_pk_add_f32 v[28:29], v[28:29], v[76:77]
  v_pk_add_f32 v[30:31], v[30:31], v[78:79]
  s_waitcnt vmcnt(0)
  v_lshlrev_b32 v80, 16, v104
  v_and_b32 v81, 0xffff0000, v104
  v_lshlrev_b32 v82, 16, v105
  v_and_b32 v83, 0xffff0000, v105
  v_lshlrev_b32 v84, 16, v106
  v_and_b32 v85, 0xffff0000, v106
  v_lshlrev_b32 v86, 16, v107
  v_and_b32 v87, 0xffff0000, v107
  v_pk_add_f32 v[32:33], v[32:33], v[80:81]
  v_pk_add_f32 v[34:35], v[34:35], v[82:83]
  v_pk_add_f32 v[36:37], v[36:37], v[84:85]
  v_pk_add_f32 v[38:39], v[38:39], v[86:87]
  v_pk_add_f32 v[44:45], v[16:17], v[18:19]
  v_pk_mul_f32 v[46:47], v[16:17], v[16:17]
  v_pk_fma_f32 v[46:47], v[18:19], v[18:19], v[46:47]
  v_pk_add_f32 v[44:45], v[44:45], v[20:21]
  v_pk_fma_f32 v[46:47], v[20:21], v[20:21], v[46:47]
  v_pk_add_f32 v[44:45], v[44:45], v[22:23]
  v_pk_fma_f32 v[46:47], v[22:23], v[22:23], v[46:47]
  v_pk_add_f32 v[44:45], v[44:45], v[24:25]
  v_pk_fma_f32 v[46:47], v[24:25], v[24:25], v[46:47]
  v_pk_add_f32 v[44:45], v[44:45], v[26:27]
  v_pk_fma_f32 v[46:47], v[26:27], v[26:27], v[46:47]
  v_pk_add_f32 v[44:45], v[44:45], v[28:29]
  v_pk_fma_f32 v[46:47], v[28:29], v[28:29], v[46:47]
  v_pk_add_f32 v[44:45], v[44:45], v[30:31]
  v_pk_fma_f32 v[46:47], v[30:31], v[30:31], v[46:47]
  v_pk_add_f32 v[44:45], v[44:45], v[32:33]
  v_pk_fma_f32 v[46:47], v[32:33], v[32:33], v[46:47]
  v_pk_add_f32 v[44:45], v[44:45], v[34:35]
  v_pk_fma_f32 v[46:47], v[34:35], v[34:35], v[46:47]
  v_pk_add_f32 v[44:45], v[44:45], v[36:37]
  v_pk_fma_f32 v[46:47], v[36:37], v[36:37], v[46:47]
  v_pk_add_f32 v[44:45], v[44:45], v[38:39]
  v_pk_fma_f32 v[46:47], v[38:39], v[38:39], v[46:47]
  v_add_f32 v44, v44, v45
  v_add_f32 v46, v46, v47
  s_nop 0
  v_add_f32_dpp v44, v44, v44 quad_perm:[2,3,0,1] row_mask:0xf bank_mask:0xf
  v_add_f32_dpp v46, v46, v46 quad_perm:[2,3,0,1] row_mask:0xf bank_mask:0xf
  s_nop 0
  v_add_f32_dpp v44, v44, v44 row_ror:4 row_mask:0xf bank_mask:0xf
  v_add_f32_dpp v46, v46, v46 row_ror:4 row_mask:0xf bank_mask:0xf
  s_nop 0
  v_add_f32_dpp v44, v44, v44 row_ror:8 row_mask:0xf bank_mask:0xf
  v_add_f32_dpp v46, v46, v46 row_ror:8 row_mask:0xf bank_mask:0xf
  s_nop 1
  v_permlane16_swap_b32 v44, v46
  v_add_f32 v44, v44, v46
  v_mov_b32 v48, v44
  s_nop 1
  v_permlane32_swap_b32 v44, v48
  v_add_f32 v44, v44, v48
  v_mov_b32 v46, v44
  s_nop 1
  v_permlane16_swap_b32 v44, v46
  v_mul_f32 v44, 0x3acccccd, v44
  v_mul_f32 v46, 0x3acccccd, v46
  v_fma_f32 v46, -v44, v44, v46
  v_max_f32 v46, 0, v46
  v_cvt_pk_bf16_f32 v48, v44, v44
  v_and_b32 v44, 0xffff0000, v48
  v_cvt_pk_bf16_f32 v50, v46, v46
  v_and_b32 v46, 0xffff0000, v50
  v_add_f32 v46, 0x3727c5ac, v46
  v_cvt_pk_bf16_f32 v50, v46, v46
  v_and_b32 v46, 0xffff0000, v50
  v_sqrt_f32 v46, v46
  s_nop 0
  v_cvt_pk_bf16_f32 v50, v46, v46
  v_and_b32 v46, 0xffff0000, v50
  v_rcp_f32 v40, v46
  s_nop 0
  v_mov_b32 v41, v40
  v_mul_f32 v42, v44, v40
  v_sub_f32 v42, 0, v42
  v_mov_b32 v43, v42
  v_pk_fma_f32 v[112:113], v[16:17], v[40:41], v[42:43]
  v_pk_fma_f32 v[114:115], v[18:19], v[40:41], v[42:43]
  v_pk_fma_f32 v[116:117], v[20:21], v[40:41], v[42:43]
  v_pk_fma_f32 v[118:119], v[22:23], v[40:41], v[42:43]
  v_pk_fma_f32 v[120:121], v[24:25], v[40:41], v[42:43]
  v_pk_fma_f32 v[122:123], v[26:27], v[40:41], v[42:43]
  v_pk_fma_f32 v[124:125], v[28:29], v[40:41], v[42:43]
  v_pk_fma_f32 v[126:127], v[30:31], v[40:41], v[42:43]
  v_pk_fma_f32 v[128:129], v[32:33], v[40:41], v[42:43]
  v_pk_fma_f32 v[130:131], v[34:35], v[40:41], v[42:43]
  v_pk_fma_f32 v[132:133], v[36:37], v[40:41], v[42:43]
  v_pk_fma_f32 v[134:135], v[38:39], v[40:41], v[42:43]
  v_pk_fma_f32 v[16:17], v[112:113], v[136:137], v[16:17]
  v_pk_fma_f32 v[18:19], v[114:115], v[138:139], v[18:19]
  v_pk_fma_f32 v[20:21], v[116:117], v[140:141], v[20:21]
  v_pk_fma_f32 v[22:23], v[118:119], v[142:143], v[22:23]
  v_pk_fma_f32 v[24:25], v[120:121], v[144:145], v[24:25]
  v_pk_fma_f32 v[26:27], v[122:123], v[146:147], v[26:27]
  v_pk_fma_f32 v[28:29], v[124:125], v[148:149], v[28:29]
  v_pk_fma_f32 v[30:31], v[126:127], v[150:151], v[30:31]
  v_pk_fma_f32 v[32:33], v[128:129], v[152:153], v[32:33]
  v_pk_fma_f32 v[34:35], v[130:131], v[154:155], v[34:35]
  v_pk_fma_f32 v[36:37], v[132:133], v[156:157], v[36:37]
  v_pk_fma_f32 v[38:39], v[134:135], v[158:159], v[38:39]
  s_cmp_lg_u32 s33, 0
  s_cbranch_scc1 L_FINAL
  v_pk_add_f32 v[44:45], v[16:17], v[18:19]
  v_pk_mul_f32 v[46:47], v[16:17], v[16:17]
  v_pk_fma_f32 v[46:47], v[18:19], v[18:19], v[46:47]
  v_pk_add_f32 v[44:45], v[44:45], v[20:21]
  v_pk_fma_f32 v[46:47], v[20:21], v[20:21], v[46:47]
  v_pk_add_f32 v[44:45], v[44:45], v[22:23]
  v_pk_fma_f32 v[46:47], v[22:23], v[22:23], v[46:47]
  v_pk_add_f32 v[44:45], v[44:45], v[24:25]
  v_pk_fma_f32 v[46:47], v[24:25], v[24:25], v[46:47]
  v_pk_add_f32 v[44:45], v[44:45], v[26:27]
  v_pk_fma_f32 v[46:47], v[26:27], v[26:27], v[46:47]
  v_pk_add_f32 v[44:45], v[44:45], v[28:29]
  v_pk_fma_f32 v[46:47], v[28:29], v[28:29], v[46:47]
  v_pk_add_f32 v[44:45], v[44:45], v[30:31]
  v_pk_fma_f32 v[46:47], v[30:31], v[30:31], v[46:47]
  v_pk_add_f32 v[44:45], v[44:45], v[32:33]
  v_pk_fma_f32 v[46:47], v[32:33], v[32:33], v[46:47]
  v_pk_add_f32 v[44:45], v[44:45], v[34:35]
  v_pk_fma_f32 v[46:47], v[34:35], v[34:35], v[46:47]
  v_pk_add_f32 v[44:45], v[44:45], v[36:37]
  v_pk_fma_f32 v[46:47], v[36:37], v[36:37], v[46:47]
  v_pk_add_f32 v[44:45], v[44:45], v[38:39]
  v_pk_fma_f32 v[46:47], v[38:39], v[38:39], v[46:47]
  v_add_f32 v44, v44, v45
  v_add_f32 v46, v46, v47
  s_nop 0
  v_add_f32_dpp v44, v44, v44 quad_perm:[2,3,0,1] row_mask:0xf bank_mask:0xf
  v_add_f32_dpp v46, v46, v46 quad_perm:[2,3,0,1] row_mask:0xf bank_mask:0xf
  s_nop 0
  v_add_f32_dpp v44, v44, v44 row_ror:4 row_mask:0xf bank_mask:0xf
  v_add_f32_dpp v46, v46, v46 row_ror:4 row_mask:0xf bank_mask:0xf
  s_nop 0
  v_add_f32_dpp v44, v44, v44 row_ror:8 row_mask:0xf bank_mask:0xf
  v_add_f32_dpp v46, v46, v46 row_ror:8 row_mask:0xf bank_mask:0xf
  s_nop 1
  v_permlane16_swap_b32 v44, v46
  v_add_f32 v44, v44, v46
  v_mov_b32 v48, v44
  s_nop 1
  v_permlane32_swap_b32 v44, v48
  v_add_f32 v44, v44, v48
  v_mov_b32 v46, v44
  s_nop 1
  v_permlane16_swap_b32 v44, v46
  v_mul_f32 v44, 0x3acccccd, v44
  v_mul_f32 v46, 0x3acccccd, v46
  v_fma_f32 v46, -v44, v44, v46
  v_max_f32 v46, 0, v46
  v_cvt_pk_bf16_f32 v48, v44, v44
  v_and_b32 v44, 0xffff0000, v48
  v_cvt_pk_bf16_f32 v50, v46, v46
  v_and_b32 v46, 0xffff0000, v50
  v_add_f32 v46, 0x3727c5ac, v46
  v_cvt_pk_bf16_f32 v50, v46, v46
  v_and_b32 v46, 0xffff0000, v50
  v_sqrt_f32 v46, v46
  s_nop 0
  v_cvt_pk_bf16_f32 v50, v46, v46
  v_and_b32 v46, 0xffff0000, v50
  v_rcp_f32 v40, v46
  s_nop 0
  v_mov_b32 v41, v40
  v_mul_f32 v42, v44, v40
  v_sub_f32 v42, 0, v42
  v_mov_b32 v43, v42
  v_pk_fma_f32 v[112:113], v[16:17], v[40:41], v[42:43]
  v_pk_fma_f32 v[114:115], v[18:19], v[40:41], v[42:43]
  v_pk_fma_f32 v[116:117], v[20:21], v[40:41], v[42:43]
  v_pk_fma_f32 v[118:119], v[22:23], v[40:41], v[42:43]
  v_pk_fma_f32 v[120:121], v[24:25], v[40:41], v[42:43]
  v_pk_fma_f32 v[122:123], v[26:27], v[40:41], v[42:43]
  v_pk_fma_f32 v[124:125], v[28:29], v[40:41], v[42:43]
  v_pk_fma_f32 v[126:127], v[30:31], v[40:41], v[42:43]
  v_pk_fma_f32 v[128:129], v[32:33], v[40:41], v[42:43]
  v_pk_fma_f32 v[130:131], v[34:35], v[40:41], v[42:43]
  v_pk_fma_f32 v[132:133], v[36:37], v[40:41], v[42:43]
  v_pk_fma_f32 v[134:135], v[38:39], v[40:41], v[42:43]
  v_cvt_pk_bf16_f32 v56, v112, v113
  v_cvt_pk_bf16_f32 v57, v114, v115
  v_cvt_pk_bf16_f32 v58, v116, v117
  v_cvt_pk_bf16_f32 v59, v118, v119
  v_cvt_pk_bf16_f32 v60, v120, v121
  v_cvt_pk_bf16_f32 v61, v122, v123
  v_cvt_pk_bf16_f32 v62, v124, v125
  v_cvt_pk_bf16_f32 v63, v126, v127
  v_cvt_pk_bf16_f32 v64, v128, v129
  v_cvt_pk_bf16_f32 v65, v130, v131
  v_cvt_pk_bf16_f32 v66, v132, v133
  v_cvt_pk_bf16_f32 v67, v134, v135
  s_cmp_lg_u32 s32, 0
  s_cbranch_scc1 L_slow_600079
  global_store_dwordx4 v8, v[56:59], s[76:77]
  global_store_dwordx4 v9, v[60:63], s[76:77]
  s_mov_b32 exec_lo, 0xffffffff
  s_mov_b32 exec_hi, 0x0
  global_store_dwordx4 v10, v[64:67], s[76:77]
  s_mov_b64 exec, -1
L_stj_600080:
  v_cvt_pk_bf16_f32 v232, v16, v17
  v_cvt_pk_bf16_f32 v233, v18, v19
  v_cvt_pk_bf16_f32 v234, v20, v21
  v_cvt_pk_bf16_f32 v235, v22, v23
  v_cvt_pk_bf16_f32 v236, v24, v25
  v_cvt_pk_bf16_f32 v237, v26, v27
  v_cvt_pk_bf16_f32 v238, v28, v29
  v_cvt_pk_bf16_f32 v239, v30, v31
  v_cvt_pk_bf16_f32 v240, v32, v33
  v_cvt_pk_bf16_f32 v241, v34, v35
  v_cvt_pk_bf16_f32 v242, v36, v37
  v_cvt_pk_bf16_f32 v243, v38, v39
  s_add_u32 s44, s34, 3
  v_mov_b32 v5, s44
  s_waitcnt vmcnt(0)
  s_barrier
  s_cmp_lg_u32 s30, 0
  s_cbranch_scc1 L_sig_600081
  s_mov_b32 exec_lo, 0x1
  s_mov_b32 exec_hi, 0x0
  s_cmp_lg_u32 s32, 0
  s_cbranch_scc1 L_slow_600082
  global_store_dword v6, v5, s[62:63]
L_stj_600083:
  s_mov_b64 exec, -1
L_sig_600081:
  s_mov_b32 s33, 1
  s_branch L_LAYER
L_FINAL:
  v_cvt_pk_bf16_f32 v232, v16, v17
  v_cvt_pk_bf16_f32 v233, v18, v19
  v_cvt_pk_bf16_f32 v234, v20, v21
  v_cvt_pk_bf16_f32 v235, v22, v23
  v_cvt_pk_bf16_f32 v236, v24, v25
  v_cvt_pk_bf16_f32 v237, v26, v27
  v_cvt_pk_bf16_f32 v238, v28, v29
  v_cvt_pk_bf16_f32 v239, v30, v31
  v_cvt_pk_bf16_f32 v240, v32, v33
  v_cvt_pk_bf16_f32 v241, v34, v35
  v_cvt_pk_bf16_f32 v242, v36, v37
  v_cvt_pk_bf16_f32 v243, v38, v39
  s_lshl_b32 s44, s28, 8
  s_lshl_b32 s45, s29, 3
  s_add_u32 s44, s44, s45
  s_lshl_b32 s45, s30, 1
  s_add_u32 s44, s44, s45
  s_mul_i32 s44, s44, 1280
  v_and_b32 v8, 1, v1
  v_mul_u32_u24 v8, 1280, v8
  v_lshrrev_b32 v9, 1, v1
  v_lshlrev_b32 v9, 4, v9
  v_add3_u32 v8, v8, v9, s44
  global_store_dwordx4 v8, v[232:235], s[22:23] nt
  global_store_dwordx4 v8, v[236:239], s[22:23] offset:512 nt
  s_mov_b32 exec_lo, 0xffffffff
  s_mov_b32 exec_hi, 0x0
  global_store_dwordx4 v8, v[240:243], s[22:23] offset:1024 nt
  s_mov_b64 exec, -1
L_END:
  s_endpgm
L_HOTEND:
L_slowr_200009:
  global_store_dwordx4 v52, v[40:43], s[26:27] sc1
  global_store_dwordx4 v53, v[44:47], s[26:27] sc1
  s_cmp_ge_u32 s30, 2
  s_cbranch_scc1 L_c0s_600084
  global_store_dwordx4 v54, v[48:51], s[26:27] sc1
L_c0s_600084:
  s_waitcnt vmcnt(0)
  s_barrier
  s_lshl_b32 s44, s28, 12
  s_add_u32 s44, s44, 0x78000
  s_add_u32 s44, s44, s26
  s_addc_u32 s45, s27, 0
  s_add_u32 s46, s31, 8
  v_mov_b32 v5, s46
  s_cmp_lg_u32 s30, 0
  s_cbranch_scc1 L_sig_600085
  s_mov_b32 exec_lo, 0x1
  s_mov_b32 exec_hi, 0x0
  global_store_dword v6, v5, s[44:45] sc1
  s_mov_b64 exec, -1
L_sig_600085:
  s_mov_b64 s[42:43], -1
L_poll_600086:
  global_load_dword v4, v15, s[44:45] sc1
  s_cmp_eq_u32 s64, 0
  s_cbranch_scc1 L_polld_600087
  s_sub_u32 s64, s64, 1
  s_waitcnt vmcnt(0)
  v_cmp_ne_u32 vcc, s46, v4
  s_nop 0
  s_and_b64 vcc, vcc, s[42:43]
  s_cbranch_scc1 L_poll_600086
L_polld_600087:
  s_branch L_slowrj_200010
L_slow_200011:
  global_store_dwordx4 v8, v[56:59], s[66:67] sc1
  global_store_dwordx4 v9, v[60:63], s[66:67] sc1
  s_mov_b32 exec_lo, 0xffffffff
  s_mov_b32 exec_hi, 0x0
  global_store_dwordx4 v10, v[64:67], s[66:67] sc1
  s_mov_b64 exec, -1
  s_branch L_stj_200012
L_slow_200014:
  global_store_dword v6, v4, s[56:57] sc1
  s_branch L_stj_200015
L_slow_600063:
  global_store_dwordx4 v160, v[48:51], s[68:69] sc1
  s_mov_b32 exec_lo, 0xffffffff
  s_mov_b32 exec_hi, 0x0
  global_store_dwordx2 v161, v[52:53], s[68:69] sc1
  s_mov_b64 exec, -1
  global_store_dwordx4 v162, v[56:59], s[68:69] sc1
  s_mov_b32 exec_lo, 0xffffffff
  s_mov_b32 exec_hi, 0x0
  global_store_dwordx2 v163, v[60:61], s[68:69] sc1
  s_mov_b64 exec, -1
  s_branch L_stj_600064
L_slow_600066:
  global_store_dword v6, v5, s[58:59] sc1
  s_branch L_stj_600067
L_slow_600072:
  global_store_dwordx4 v12, v[56:59], s[66:67] sc1
  global_store_dwordx4 v12, v[60:63], s[66:67] offset:2048 sc1
  s_mov_b32 exec_lo, 0xffff
  s_mov_b32 exec_hi, 0xffff
  global_store_dwordx4 v13, v[64:67], s[66:67] sc1
  s_mov_b64 exec, -1
  s_branch L_stj_600073
L_slow_600075:
  global_store_dword v6, v5, s[60:61] sc1
  s_branch L_stj_600076
L_slow_600079:
  global_store_dwordx4 v8, v[56:59], s[76:77] sc1
  global_store_dwordx4 v9, v[60:63], s[76:77] sc1
  s_mov_b32 exec_lo, 0xffffffff
  s_mov_b32 exec_hi, 0x0
  global_store_dwordx4 v10, v[64:67], s[76:77] sc1
  s_mov_b64 exec, -1
  s_branch L_stj_600080
L_slow_600082:
  global_store_dword v6, v5, s[62:63] sc1
  s_branch L_stj_600083
L_fb_600059:
  v_mov_b32 v96, v80
  v_mov_b32 v97, v81
  v_mov_b32 v98, v82
  v_mov_b32 v99, v83
  v_mov_b32 v100, v84
  v_mov_b32 v101, v85
  s_mov_b32 s88, s30
  s_mov_b32 s52, 0
  s_branch L_fbody_600088
L_fb_600061:
  v_mov_b32 v96, v86
  v_mov_b32 v97, v87
  v_mov_b32 v98, v88
  v_mov_b32 v99, v89
  v_mov_b32 v100, v90
  v_mov_b32 v101, v91
  s_sub_u32 s88, 7, s30
  s_mov_b32 s52, 1
  s_branch L_fbody_600088
L_fbody_600088:
  v_add_u32 v8, 81920, v2
  s_mov_b32 s94, 28
L_frl_600090:
  global_load_dwordx4 v[136:139], v8, s[72:73] sc1
  s_waitcnt vmcnt(0)
  ds_write_b128 v8, v[136:139]
  v_add_u32 v8, 1024, v8
  s_sub_u32 s94, s94, 1
  s_cmp_lg_u32 s94, 0
  s_cbranch_scc1 L_frl_600090
  s_waitcnt lgkmcnt(0)
  v_mov_b32 v120, 0xff61b1e6
  v_mov_b32 v121, 0xff61b1e6
  v_mov_b32 v122, 0xff61b1e6
  v_mov_b32 v123, 0xff61b1e6
  v_mov_b32 v124, 0xff61b1e6
  v_mov_b32 v125, 0xff61b1e6
  v_mov_b32 v126, 0xff61b1e6
  v_mov_b32 v127, 0xff61b1e6
  v_mov_b32 v128, 0xff61b1e6
  v_mov_b32 v129, 0xff61b1e6
  v_mov_b32 v130, 0xff61b1e6
  v_mov_b32 v131, 0xff61b1e6
  v_mov_b32 v132, 0xff61b1e6
  v_mov_b32 v133, 0xff61b1e6
  v_mov_b32 v134, 0xff61b1e6
  v_mov_b32 v135, 0xff61b1e6
  v_mov_b32 v104, 0
  v_mov_b32 v105, 0
  v_mov_b32 v106, 0
  v_mov_b32 v107, 0
  v_mov_b32 v108, 0
  v_mov_b32 v109, 0
  v_mov_b32 v110, 0
  v_mov_b32 v111, 0
  v_mov_b32 v112, 0
  v_mov_b32 v113, 0
  v_mov_b32 v114, 0
  v_mov_b32 v115, 0
  v_mov_b32 v116, 0
  v_mov_b32 v117, 0
  v_mov_b32 v118, 0
  v_mov_b32 v119, 0
  s_mov_b32 s95, 0
L_fp_600091:
  s_mov_b32 s89, 0
L_fph_600092:
  s_cmp_lg_u32 s89, 0
  s_cbranch_scc1 L_f_600099
  v_and_b32 v4, 31, v1
  v_lshrrev_b32 v5, 5, v1
  v_lshlrev_b32 v5, 2, v5
  v_sub_u32 v4, v4, v5
  v_mov_b32 v5, 0xf149f2ca
  v_cmp_le_i32 s[80:81], 0, v4
  v_cmp_le_i32 s[82:83], 1, v4
  s_nop 0
  v_cndmask_b32 v208, v5, 0, s[80:81]
  v_cmp_le_i32 s[84:85], 2, v4
  v_cndmask_b32 v209, v5, 0, s[82:83]
  v_cmp_le_i32 s[86:87], 3, v4
  v_cndmask_b32 v210, v5, 0, s[84:85]
  v_cmp_le_i32 s[80:81], 8, v4
  v_cndmask_b32 v211, v5, 0, s[86:87]
  v_cmp_le_i32 s[82:83], 9, v4
  v_cndmask_b32 v212, v5, 0, s[80:81]
  v_cmp_le_i32 s[84:85], 10, v4
  v_cndmask_b32 v213, v5, 0, s[82:83]
  v_cmp_le_i32 s[86:87], 11, v4
  v_cndmask_b32 v214, v5, 0, s[84:85]
  v_cmp_le_i32 s[80:81], 16, v4
  v_cndmask_b32 v215, v5, 0, s[86:87]
  v_cmp_le_i32 s[82:83], 17, v4
  v_cndmask_b32 v216, v5, 0, s[80:81]
  v_cmp_le_i32 s[84:85], 18, v4
  v_cndmask_b32 v217, v5, 0, s[82:83]
  v_cmp_le_i32 s[86:87], 19, v4
  v_cndmask_b32 v218, v5, 0, s[84:85]
  v_cmp_le_i32 s[80:81], 24, v4
  v_cndmask_b32 v219, v5, 0, s[86:87]
  v_cmp_le_i32 s[82:83], 25, v4
  v_cndmask_b32 v220, v5, 0, s[80:81]
  v_cmp_le_i32 s[84:85], 26, v4
  v_cndmask_b32 v221, v5, 0, s[82:83]
  v_cmp_le_i32 s[86:87], 27, v4
  v_cndmask_b32 v222, v5, 0, s[84:85]
  s_nop 0
  v_cndmask_b32 v223, v5, 0, s[86:87]
  s_mov_b32 s92, 81920
  s_mov_b32 s93, 94208
  s_add_u32 s90, s88, 1
  s_mov_b32 s91, s88
  s_branch L_f_600100
L_f_600099:
  v_and_b32 v4, 31, v1
  v_lshrrev_b32 v5, 5, v1
  v_lshlrev_b32 v5, 2, v5
  v_sub_u32 v4, v4, v5
  v_mov_b32 v5, 0xf149f2ca
  v_cmp_le_i32 s[80:81], 0, v4
  v_cmp_le_i32 s[82:83], 1, v4
  s_nop 0
  v_cndmask_b32 v208, 0, v5, s[80:81]
  v_cmp_le_i32 s[84:85], 2, v4
  v_cndmask_b32 v209, 0, v5, s[82:83]
  v_cmp_le_i32 s[86:87], 3, v4
  v_cndmask_b32 v210, 0, v5, s[84:85]
  v_cmp_le_i32 s[80:81], 8, v4
  v_cndmask_b32 v211, 0, v5, s[86:87]
  v_cmp_le_i32 s[82:83], 9, v4
  v_cndmask_b32 v212, 0, v5, s[80:81]
  v_cmp_le_i32 s[84:85], 10, v4
  v_cndmask_b32 v213, 0, v5, s[82:83]
  v_cmp_le_i32 s[86:87], 11, v4
  v_cndmask_b32 v214, 0, v5, s[84:85]
  v_cmp_le_i32 s[80:81], 16, v4
  v_cndmask_b32 v215, 0, v5, s[86:87]
  v_cmp_le_i32 s[82:83], 17, v4
  v_cndmask_b32 v216, 0, v5, s[80:81]
  v_cmp_le_i32 s[84:85], 18, v4
  v_cndmask_b32 v217, 0, v5, s[82:83]
  v_cmp_le_i32 s[86:87], 19, v4
  v_cndmask_b32 v218, 0, v5, s[84:85]
  v_cmp_le_i32 s[80:81], 24, v4
  v_cndmask_b32 v219, 0, v5, s[86:87]
  v_cmp_le_i32 s[82:83], 25, v4
  v_cndmask_b32 v220, 0, v5, s[80:81]
  v_cmp_le_i32 s[84:85], 26, v4
  v_cndmask_b32 v221, 0, v5, s[82:83]
  v_cmp_le_i32 s[86:87], 27, v4
  v_cndmask_b32 v222, 0, v5, s[84:85]
  s_nop 0
  v_cndmask_b32 v223, 0, v5, s[86:87]
  s_mul_i32 s92, s88, 1536
  s_add_u32 s92, s92, 135168
  s_lshl_b32 s93, s88, 11
  s_add_u32 s93, s93, 147456
  s_sub_u32 s90, 8, s88
  s_mov_b32 s91, 0
L_f_600100:
  v_add_u32 v8, s92, v2
  v_add_u32 v9, s92, v3
  v_add_u32 v10, s93, v2
  s_mov_b32 s94, 0
L_fi_600093:
  ds_read_b128 v[56:59], v8
  ds_read_b64 v[60:61], v9 offset:1024
  ds_read_b128 v[62:65], v10
  ds_read_b128 v[66:69], v10 offset:1024
  s_waitcnt lgkmcnt(0)
  s_cmp_eq_u32 s94, s91
  s_cbranch_scc0 L_fn_600094
  v_mfma_f32_32x32x16_bf16 v[16:31], v[56:59], v[96:99], v[208:223]
  s_branch L_fj_600095
L_fn_600094:
  v_mfma_f32_32x32x16_bf16 v[16:31], v[56:59], v[96:99], 0
L_fj_600095:
  v_mfma_f32_32x32x8_bf16 v[16:31], v[60:61], v[100:101], v[16:31]
  s_cmp_lg_u32 s95, 0
  s_cbranch_scc1 L_fa_600096
  s_nop 9
  v_max_f32 v120, v120, v16
  v_max_f32 v121, v121, v17
  v_max_f32 v122, v122, v18
  v_max_f32 v123, v123, v19
  v_max_f32 v124, v124, v20
  v_max_f32 v125, v125, v21
  v_max_f32 v126, v126, v22
  v_max_f32 v127, v127, v23
  v_max_f32 v128, v128, v24
  v_max_f32 v129, v129, v25
  v_max_f32 v130, v130, v26
  v_max_f32 v131, v131, v27
  v_max_f32 v132, v132, v28
  v_max_f32 v133, v133, v29
  v_max_f32 v134, v134, v30
  v_max_f32 v135, v135, v31
  s_branch L_fx_600097
L_fa_600096:
  s_nop 9
  v_sub_f32 v16, v16, v120
  v_exp_f32 v16, v16
  v_sub_f32 v17, v17, v120
  v_exp_f32 v17, v17
  v_sub_f32 v18, v18, v120
  v_exp_f32 v18, v18
  v_sub_f32 v19, v19, v120
  s_nop 2
  v_exp_f32 v19, v19
  v_sub_f32 v20, v20, v120
  v_exp_f32 v20, v20
  v_sub_f32 v21, v21, v120
  v_exp_f32 v21, v21
  v_sub_f32 v22, v22, v120
  v_exp_f32 v22, v22
  v_sub_f32 v23, v23, v120
  v_exp_f32 v23, v23
  v_sub_f32 v24, v24, v120
  v_exp_f32 v24, v24
  v_sub_f32 v25, v25, v120
  v_exp_f32 v25, v25
  v_sub_f32 v26, v26, v120
  v_exp_f32 v26, v26
  v_sub_f32 v27, v27, v120
  v_exp_f32 v27, v27
  v_sub_f32 v28, v28, v120
  v_exp_f32 v28, v28
  v_sub_f32 v29, v29, v120
  v_exp_f32 v29, v29
  v_sub_f32 v30, v30, v120
  v_exp_f32 v30, v30
  v_sub_f32 v31, v31, v120
  v_exp_f32 v31, v31
  v_cvt_pk_bf16_f32 v48, v16, v17
  v_cvt_pk_bf16_f32 v49, v18, v19
  v_cvt_pk_bf16_f32 v50, v20, v21
  v_cvt_pk_bf16_f32 v51, v22, v23
  v_cvt_pk_bf16_f32 v52, v24, v25
  v_cvt_pk_bf16_f32 v53, v26, v27
  v_cvt_pk_bf16_f32 v54, v28, v29
  v_cvt_pk_bf16_f32 v55, v30, v31
  v_mfma_f32_32x32x16_bf16 v[104:119], v[62:65], v[48:51], v[104:119]
  s_nop 0
  v_mfma_f32_32x32x16_bf16 v[104:119], v[66:69], v[52:55], v[104:119]
L_fx_600097:
  v_add_u32 v8, 1536, v8
  v_add_u32 v9, 1536, v9
  v_add_u32 v10, 2048, v10
  s_add_u32 s94, s94, 1
  s_cmp_lt_u32 s94, s90
  s_cbranch_scc1 L_fi_600093
  s_cmp_eq_u32 s28, 0
  s_cbranch_scc1 L_fe_600098
  s_add_u32 s89, s89, 1
  s_cmp_lt_u32 s89, 2
  s_cbranch_scc1 L_fph_600092
L_fe_600098:
  s_cmp_lg_u32 s95, 0
  s_cbranch_scc1 L_fdone_600089
  v_max_f32 v120, v120, v121
  v_max_f32 v120, v120, v122
  v_max_f32 v120, v120, v123
  v_max_f32 v120, v120, v124
  v_max_f32 v120, v120, v125
  v_max_f32 v120, v120, v126
  v_max_f32 v120, v120, v127
  v_max_f32 v120, v120, v128
  v_max_f32 v120, v120, v129
  v_max_f32 v120, v120, v130
  v_max_f32 v120, v120, v131
  v_max_f32 v120, v120, v132
  v_max_f32 v120, v120, v133
  v_max_f32 v120, v120, v134
  v_max_f32 v120, v120, v135
  v_mov_b32 v121, v120
  s_nop 1
  v_permlane32_swap_b32 v120, v121
  v_max_f32 v120, v120, v121
  s_mov_b32 s95, 1
  s_branch L_fp_600091
L_fdone_600089:
  s_cmp_lg_u32 s52, 0
  s_cbranch_scc1 L_fo_600101
  v_mov_b32 v176, v104
  v_mov_b32 v177, v105
  v_mov_b32 v178, v106
  v_mov_b32 v179, v107
  v_mov_b32 v180, v108
  v_mov_b32 v181, v109
  v_mov_b32 v182, v110
  v_mov_b32 v183, v111
  v_mov_b32 v184, v112
  v_mov_b32 v185, v113
  v_mov_b32 v186, v114
  v_mov_b32 v187, v115
  v_mov_b32 v188, v116
  v_mov_b32 v189, v117
  v_mov_b32 v190, v118
  v_mov_b32 v191, v119
  s_branch L_fbr_600060
L_fo_600101:
  v_mov_b32 v192, v104
  v_mov_b32 v193, v105
  v_mov_b32 v194, v106
  v_mov_b32 v195, v107
  v_mov_b32 v196, v108
  v_mov_b32 v197, v109
  v_mov_b32 v198, v110
  v_mov_b32 v199, v111
  v_mov_b32 v200, v112
  v_mov_b32 v201, v113
  v_mov_b32 v202, v114
  v_mov_b32 v203, v115
  v_mov_b32 v204, v116
  v_mov_b32 v205, v117
  v_mov_b32 v206, v118
  v_mov_b32 v207, v119
  s_branch L_fbr_600062
  s_endpgm
.section .rodata,"a"
.p2align 6
.amdhsa_kernel interleave_layers__sliding_block__ssm_conv_h3__prompt_kernel
  .amdhsa_next_free_vgpr 512
  .amdhsa_next_free_sgpr 102
  .amdhsa_accum_offset 256
  .amdhsa_group_segment_fixed_size 0
  .amdhsa_kernarg_size 96
  .amdhsa_user_sgpr_count 2
  .amdhsa_user_sgpr_kernarg_segment_ptr 1
  .amdhsa_system_sgpr_workgroup_id_x 1
  .amdhsa_float_denorm_mode_32 3
.end_amdhsa_kernel
```
